```python
import torch

def _softmax(x, axis=-1):
    return torch.softmax(x, dim=axis)
def _gelu(x):
    return torch.nn.functional.gelu(x, approximate="tanh")
def _silu(x):
    return torch.nn.functional.silu(x)
def _sigmoid(x):
    return torch.sigmoid(x)
def _layernorm(x, axis=-1, eps=1e-5):
    m = x.mean(dim=axis, keepdim=True)
    v = x.var(dim=axis, keepdim=True, unbiased=False)
    return (x - m) / torch.sqrt(v + eps)
def _scatter_add(tgt, idx, src, axis=0):
    return tgt.clone().index_add_(axis, idx, src)
def _segment_sum(src, seg, n):
    out = torch.zeros((n,) + src.shape[1:], dtype=src.dtype)
    return out.index_add_(0, seg, src)
def _pad(x, pw):
    flat = tuple(v for pair in reversed(pw) for v in pair)
    return torch.nn.functional.pad(x, flat)

kernel_name = 'sequential_preLN__spectral_fnet__moe_arch_mod__prompt'

def setup_inputs():

    _w = (lambda a: (lambda t: t.to(torch.bfloat16) if t.is_floating_point() else t)(torch.as_tensor(a)))
    def _A_setup():
        B, S, D = 1, 2048, 512
        ns = torch.arange(S)[:, None] * torch.arange(S)[None, :]
        nd = torch.arange(D)[:, None] * torch.arange(D)[None, :]
        Ws_re = torch.cos(-2.0 * torch.pi * ns / S).to(float)
        Ws_im = torch.sin(-2.0 * torch.pi * ns / S).to(float)
        Wd_re = torch.cos(-2.0 * torch.pi * nd / D).to(float)
        Wd_im = torch.sin(-2.0 * torch.pi * nd / D).to(float)
        return {
            "x": _w((lambda *s: torch.randn(*s, dtype=torch.bfloat16) * 0.05)(B, S, D)),
            "dft_seq_re": _w(Ws_re),
            "dft_seq_im": _w(Ws_im),
            "dft_hid_re": _w(Wd_re),
            "dft_hid_im": _w(Wd_im),
        }
    _A_in = _A_setup()

    def _B_setup():
        B, S, D, F, C = 1, 2048, 512, 1792, 1
        return {
            "x": _w((lambda *s: torch.randn(*s, dtype=torch.bfloat16) * 0.05)(B, S, D)),
            "w_r": _w((lambda *s: torch.randn(*s, dtype=torch.bfloat16) * 1.6)(D)),
            "w_gate": _w((lambda *s: torch.randn(*s, dtype=torch.bfloat16) * 0.4)(D, F)),
            "w_up": _w((lambda *s: torch.randn(*s, dtype=torch.bfloat16) * 0.4)(D, F)),
            "w_down": _w((lambda *s: torch.randn(*s, dtype=torch.bfloat16) * 0.4)(F, D)),
        }
    _B_in = _B_setup()

    return {
        "A_x": _A_in["x"],
        "A_dft_seq_re": _A_in["dft_seq_re"],
        "A_dft_seq_im": _A_in["dft_seq_im"],
        "A_dft_hid_re": _A_in["dft_hid_re"],
        "A_dft_hid_im": _A_in["dft_hid_im"],
        "B_x": _B_in["x"],
        "B_w_r": _B_in["w_r"],
        "B_w_gate": _B_in["w_gate"],
        "B_w_up": _B_in["w_up"],
        "B_w_down": _B_in["w_down"],
    }

def reference(A_x, A_dft_seq_re, A_dft_seq_im, A_dft_hid_re, A_dft_hid_im, B_x, B_w_r, B_w_gate, B_w_up, B_w_down):
    def _A_ref(x, dft_seq_re, dft_seq_im, dft_hid_re, dft_hid_im):
        a = torch.einsum("bsd,ed->bse", x, dft_hid_re)
        b = torch.einsum("bsd,ed->bse", x, dft_hid_im)
        y = torch.einsum("ts,bse->bte", dft_seq_re, a) - torch.einsum("ts,bse->bte", dft_seq_im, b)
        return y

    def _B_ref(x, w_r, w_gate, w_up, w_down):
        B, S, D = x.shape
        C = 1
        r = x @ w_r
        idx = torch.argsort(-r, axis=-1)[:, :C]
        idx_e = (lambda x, n, axis: torch.repeat_interleave(x, n, dim=axis))(idx.reshape(B, C, 1), D, axis=2)
        x_sel = (lambda x, i, axis: torch.take_along_dim(x, i, dim=axis))(x, idx_e, axis=1)
        g = _silu(x_sel @ w_gate)
        u = x_sel @ w_up
        y = (g * u) @ w_down
        r_sel = _sigmoid((lambda x, i, axis: torch.take_along_dim(x, i, dim=axis))(r, idx, axis=1))
        y = y * r_sel.reshape(B, C, 1)
        b_off = (torch.arange(B) * S).reshape(B, 1)
        flat_idx = (idx + b_off).reshape(B * C)
        zero = (x * 0.0).reshape(B * S, D)
        upd = _scatter_add(zero, flat_idx, y.reshape(B * C, D), axis=0)
        return x + upd.reshape(B, S, D)

    x = A_x
    h = x + _A_ref(_layernorm(x, axis=-1), A_dft_seq_re, A_dft_seq_im, A_dft_hid_re, A_dft_hid_im)
    h2 = h + _B_ref(_layernorm(h, axis=-1), B_w_r, B_w_gate, B_w_up, B_w_down)
    return h2
```

```asm
; @launch kernel=k1_kernel grid=(256,1,1) block=(512,1,1) lds=163840
.amdgcn_target "amdgcn-amd-amdhsa--gfx950"
.text
.globl k1_kernel
.p2align 8
.type k1_kernel,@function
k1_kernel:
    s_cmp_ge_u32 s2, 256
    s_cbranch_scc1 k1_kernel_done
    s_load_dwordx2 s[4:5], s[0:1], 0
    s_load_dwordx4 s[8:11], s[0:1], 24
    s_load_dwordx4 s[44:47], s[0:1], 88
    s_load_dwordx4 s[40:43], s[0:1], 8
    s_and_b32 s3, s2, 7
    s_lshr_b32 s28, s2, 4
    s_and_b32 s29, s3, 1
    s_bfe_u32 s27, s3, 0x10001
    s_lshr_b32 s26, s3, 2
    s_lshl_b32 s30, s27, 3
    s_lshl_b32 s34, s26, 2
    s_add_u32 s30, s30, s34
    s_and_b32 s34, s28, 3
    s_add_u32 s30, s30, s34
    s_lshr_b32 s31, s28, 2
    v_lshrrev_b32 v1, 6, v0
    v_and_b32 v2, 63, v0
    s_nop 0
    v_readfirstlane_b32 s32, v1
    s_mov_b32 s53, 0xffff0000
    s_mov_b32 s69, 0x40000
    s_bitcmp1_b32 s2, 3
    s_cbranch_scc1 k1_kernel_aux
    s_xor_b32 s32, s32, 4
    s_cmp_lt_u32 s32, 4
    s_cbranch_scc1 k1_kernel_cons
    s_sub_u32 s33, s32, 4
    v_lshrrev_b32 v3, 3, v2
    v_and_b32 v4, 7, v2
    v_bfe_u32 v5, v2, 4, 1
    v_xor_b32 v4, v4, v5
    v_lshlrev_b32 v3, 10, v3
    v_xor_b32 v8, 0, v4
    v_lshl_add_u32 v8, v8, 4, v3
    v_xor_b32 v9, 3, v4
    v_lshl_add_u32 v9, v9, 4, v3
    v_add_u32 v9, 7168, v9
    v_xor_b32 v10, 5, v4
    v_lshl_add_u32 v10, v10, 4, v3
    v_add_u32 v10, 14336, v10
    v_xor_b32 v11, 6, v4
    v_lshl_add_u32 v11, v11, 4, v3
    v_add_u32 v11, 21504, v11
    s_lshl_b32 s34, s33, 5
    s_lshl_b32 s35, s30, 7
    s_add_u32 s35, s35, s34
    s_lshl_b32 s35, s35, 10
    s_lshl_b32 s36, s31, 7
    s_add_u32 s36, s36, s34
    s_lshl_b32 s36, s36, 10
    s_lshl_b32 s37, s33, 12
    v_lshlrev_b32 v12, 6, v2
    v_add_u32 v12, s37, v12
    v_add_u32 v12, 16384, v12
    v_add_u32 v13, 65536, v12
    v_add_u32 v6, 131072, v12
    v_mov_b32 v14, 0
    v_mov_b32 v15, 0
    s_mov_b32 s50, 0x3f803f80
    s_waitcnt lgkmcnt(0)
    s_mov_b32 s12, s4
    s_and_b32 s13, s5, 0xffff
    s_mov_b32 s14, 2097152
    s_mov_b32 s15, 0x00020000
    s_cmp_eq_u32 s29, 1
    s_cselect_b32 s8, s10, s8
    s_cselect_b32 s9, s11, s9
    s_mov_b32 s16, s8
    s_and_b32 s17, s9, 0xffff
    s_mov_b32 s18, 524288
    s_mov_b32 s19, 0x00020000
    s_add_u32 m0, s37, 0
    s_add_u32 s39, s35, 0
    buffer_load_dwordx4 v8, s[12:15], s39 offen offset:0 lds
    buffer_load_dwordx4 v9, s[12:15], s39 offen offset:1024 lds
    buffer_load_dwordx4 v10, s[12:15], s39 offen offset:2048 lds
    buffer_load_dwordx4 v11, s[12:15], s39 offen offset:3072 lds
    s_add_u32 m0, s37, 16384
    s_add_u32 s39, s36, 0
    buffer_load_dwordx4 v8, s[16:19], s39 offen offset:0 lds
    buffer_load_dwordx4 v9, s[16:19], s39 offen offset:1024 lds
    buffer_load_dwordx4 v10, s[16:19], s39 offen offset:2048 lds
    buffer_load_dwordx4 v11, s[16:19], s39 offen offset:3072 lds
    s_add_u32 m0, s37, 32768
    s_add_u32 s39, s35, 128
    buffer_load_dwordx4 v8, s[12:15], s39 offen offset:0 lds
    buffer_load_dwordx4 v9, s[12:15], s39 offen offset:1024 lds
    buffer_load_dwordx4 v10, s[12:15], s39 offen offset:2048 lds
    buffer_load_dwordx4 v11, s[12:15], s39 offen offset:3072 lds
    s_add_u32 m0, s37, 49152
    s_add_u32 s39, s36, 128
    buffer_load_dwordx4 v8, s[16:19], s39 offen offset:0 lds
    buffer_load_dwordx4 v9, s[16:19], s39 offen offset:1024 lds
    buffer_load_dwordx4 v10, s[16:19], s39 offen offset:2048 lds
    buffer_load_dwordx4 v11, s[16:19], s39 offen offset:3072 lds
    s_add_u32 m0, s37, 65536
    s_add_u32 s39, s35, 256
    buffer_load_dwordx4 v8, s[12:15], s39 offen offset:0 lds
    buffer_load_dwordx4 v9, s[12:15], s39 offen offset:1024 lds
    buffer_load_dwordx4 v10, s[12:15], s39 offen offset:2048 lds
    buffer_load_dwordx4 v11, s[12:15], s39 offen offset:3072 lds
    s_add_u32 m0, s37, 81920
    s_add_u32 s39, s36, 256
    buffer_load_dwordx4 v8, s[16:19], s39 offen offset:0 lds
    buffer_load_dwordx4 v9, s[16:19], s39 offen offset:1024 lds
    buffer_load_dwordx4 v10, s[16:19], s39 offen offset:2048 lds
    buffer_load_dwordx4 v11, s[16:19], s39 offen offset:3072 lds
    s_waitcnt vmcnt(16)
    s_barrier
    s_add_u32 m0, s37, 98304
    s_add_u32 s39, s35, 384
    buffer_load_dwordx4 v8, s[12:15], s39 offen offset:0 lds
    buffer_load_dwordx4 v9, s[12:15], s39 offen offset:1024 lds
    buffer_load_dwordx4 v10, s[12:15], s39 offen offset:2048 lds
    buffer_load_dwordx4 v11, s[12:15], s39 offen offset:3072 lds
    s_add_u32 m0, s37, 114688
    s_add_u32 s39, s36, 384
    buffer_load_dwordx4 v8, s[16:19], s39 offen offset:0 lds
    buffer_load_dwordx4 v9, s[16:19], s39 offen offset:1024 lds
    buffer_load_dwordx4 v10, s[16:19], s39 offen offset:2048 lds
    buffer_load_dwordx4 v11, s[16:19], s39 offen offset:3072 lds
    s_add_u32 m0, s37, 131072
    s_add_u32 s39, s35, 512
    buffer_load_dwordx4 v8, s[12:15], s39 offen offset:0 lds
    buffer_load_dwordx4 v9, s[12:15], s39 offen offset:1024 lds
    buffer_load_dwordx4 v10, s[12:15], s39 offen offset:2048 lds
    buffer_load_dwordx4 v11, s[12:15], s39 offen offset:3072 lds
    s_add_u32 m0, s37, 147456
    s_add_u32 s39, s36, 512
    buffer_load_dwordx4 v8, s[16:19], s39 offen offset:0 lds
    buffer_load_dwordx4 v9, s[16:19], s39 offen offset:1024 lds
    buffer_load_dwordx4 v10, s[16:19], s39 offen offset:2048 lds
    buffer_load_dwordx4 v11, s[16:19], s39 offen offset:3072 lds
    s_waitcnt vmcnt(24)
    s_barrier
    s_add_u32 m0, s37, 0
    s_add_u32 s39, s35, 640
    buffer_load_dwordx4 v8, s[12:15], s39 offen offset:0 lds
    buffer_load_dwordx4 v9, s[12:15], s39 offen offset:1024 lds
    buffer_load_dwordx4 v10, s[12:15], s39 offen offset:2048 lds
    buffer_load_dwordx4 v11, s[12:15], s39 offen offset:3072 lds
    s_add_u32 m0, s37, 16384
    s_add_u32 s39, s36, 640
    buffer_load_dwordx4 v8, s[16:19], s39 offen offset:0 lds
    buffer_load_dwordx4 v9, s[16:19], s39 offen offset:1024 lds
    buffer_load_dwordx4 v10, s[16:19], s39 offen offset:2048 lds
    buffer_load_dwordx4 v11, s[16:19], s39 offen offset:3072 lds
    s_waitcnt vmcnt(24)
    s_barrier
    s_add_u32 m0, s37, 32768
    s_add_u32 s39, s35, 768
    buffer_load_dwordx4 v8, s[12:15], s39 offen offset:0 lds
    buffer_load_dwordx4 v9, s[12:15], s39 offen offset:1024 lds
    buffer_load_dwordx4 v10, s[12:15], s39 offen offset:2048 lds
    buffer_load_dwordx4 v11, s[12:15], s39 offen offset:3072 lds
    s_add_u32 m0, s37, 49152
    s_add_u32 s39, s36, 768
    buffer_load_dwordx4 v8, s[16:19], s39 offen offset:0 lds
    buffer_load_dwordx4 v9, s[16:19], s39 offen offset:1024 lds
    buffer_load_dwordx4 v10, s[16:19], s39 offen offset:2048 lds
    buffer_load_dwordx4 v11, s[16:19], s39 offen offset:3072 lds
    s_waitcnt vmcnt(24)
    s_barrier
    s_add_u32 m0, s37, 65536
    s_add_u32 s39, s35, 896
    buffer_load_dwordx4 v8, s[12:15], s39 offen offset:0 lds
    buffer_load_dwordx4 v9, s[12:15], s39 offen offset:1024 lds
    buffer_load_dwordx4 v10, s[12:15], s39 offen offset:2048 lds
    buffer_load_dwordx4 v11, s[12:15], s39 offen offset:3072 lds
    s_add_u32 m0, s37, 81920
    s_add_u32 s39, s36, 896
    buffer_load_dwordx4 v8, s[16:19], s39 offen offset:0 lds
    buffer_load_dwordx4 v9, s[16:19], s39 offen offset:1024 lds
    buffer_load_dwordx4 v10, s[16:19], s39 offen offset:2048 lds
    buffer_load_dwordx4 v11, s[16:19], s39 offen offset:3072 lds
    s_waitcnt vmcnt(24)
    s_barrier
    s_waitcnt vmcnt(16)
    s_barrier
    s_waitcnt vmcnt(8)
    s_barrier
    s_waitcnt vmcnt(0)
    s_barrier
    s_barrier
    s_branch k1_kernel_fin
k1_kernel_cons:
    s_and_b32 s33, s32, 1
    s_lshr_b32 s34, s32, 1
    v_and_b32 v4, 15, v2
    v_lshrrev_b32 v6, 4, v2
    v_lshrrev_b32 v5, 2, v4
    v_and_b32 v7, 3, v4
    v_lshl_add_u32 v7, v5, 3, v7
    v_lshrrev_b32 v20, 1, v4
    v_lshrrev_b32 v21, 2, v4
    v_lshrrev_b32 v22, 3, v4
    v_xor_b32 v21, v21, v22
    v_and_b32 v21, 1, v21
    v_xor_b32 v20, v20, v21
    v_xor_b32 v20, v20, v6
    v_lshlrev_b32 v20, 4, v20
    v_lshl_add_u32 v20, v7, 7, v20
    s_lshl_b32 s35, s33, 13
    s_lshl_b32 s36, s34, 13
    s_add_u32 s36, s36, 16384
    v_add_u32 v8, s35, v20
    v_xor_b32 v9, 64, v8
    v_add_u32 v10, s36, v20
    v_xor_b32 v11, 64, v10
    v_add_u32 v12, s35, v20
    v_xor_b32 v13, 64, v12
    v_add_u32 v14, s36, v20
    v_xor_b32 v15, 64, v14
    v_add_u32 v12, 65536, v12
    v_add_u32 v13, 65536, v13
    v_add_u32 v14, 65536, v14
    v_add_u32 v15, 65536, v15
    v_add_u32 v16, s35, v20
    v_xor_b32 v17, 64, v16
    v_add_u32 v18, s36, v20
    v_xor_b32 v19, 64, v18
    v_add_u32 v16, 131072, v16
    v_add_u32 v17, 131072, v17
    v_add_u32 v18, 131072, v18
    v_add_u32 v19, 131072, v19
    v_mov_b32 v32, 0
    v_mov_b32 v33, 0
    v_mov_b32 v34, 0
    v_mov_b32 v35, 0
    v_mov_b32 v36, 0
    v_mov_b32 v37, 0
    v_mov_b32 v38, 0
    v_mov_b32 v39, 0
    v_mov_b32 v40, 0
    v_mov_b32 v41, 0
    v_mov_b32 v42, 0
    v_mov_b32 v43, 0
    v_mov_b32 v44, 0
    v_mov_b32 v45, 0
    v_mov_b32 v46, 0
    v_mov_b32 v47, 0
    v_mov_b32 v48, 0
    v_mov_b32 v49, 0
    v_mov_b32 v50, 0
    v_mov_b32 v51, 0
    v_mov_b32 v52, 0
    v_mov_b32 v53, 0
    v_mov_b32 v54, 0
    v_mov_b32 v55, 0
    v_mov_b32 v56, 0
    v_mov_b32 v57, 0
    v_mov_b32 v58, 0
    v_mov_b32 v59, 0
    v_mov_b32 v60, 0
    v_mov_b32 v61, 0
    v_mov_b32 v62, 0
    v_mov_b32 v63, 0
    v_mov_b32 v64, 0
    v_mov_b32 v65, 0
    v_mov_b32 v66, 0
    v_mov_b32 v67, 0
    v_mov_b32 v68, 0
    v_mov_b32 v69, 0
    v_mov_b32 v70, 0
    v_mov_b32 v71, 0
    v_mov_b32 v72, 0
    v_mov_b32 v73, 0
    v_mov_b32 v74, 0
    v_mov_b32 v75, 0
    v_mov_b32 v76, 0
    v_mov_b32 v77, 0
    v_mov_b32 v78, 0
    v_mov_b32 v79, 0
    v_mov_b32 v80, 0
    v_mov_b32 v81, 0
    v_mov_b32 v82, 0
    v_mov_b32 v83, 0
    v_mov_b32 v84, 0
    v_mov_b32 v85, 0
    v_mov_b32 v86, 0
    v_mov_b32 v87, 0
    v_mov_b32 v88, 0
    v_mov_b32 v89, 0
    v_mov_b32 v90, 0
    v_mov_b32 v91, 0
    v_mov_b32 v92, 0
    v_mov_b32 v93, 0
    v_mov_b32 v94, 0
    v_mov_b32 v95, 0
    s_lshl_b32 s38, s30, 7
    s_lshl_b32 s39, s33, 6
    s_add_u32 s38, s38, s39
    s_lshl_b32 s38, s38, 3
    s_add_u32 s38, s38, 13115392
    v_lshlrev_b32 v23, 6, v6
    v_mov_b32 v24, 0
    s_lshl_b32 s39, s29, 9
    s_lshl_b32 s61, s31, 7
    s_add_u32 s39, s39, s61
    s_lshl_b32 s61, s34, 6
    s_add_u32 s39, s39, s61
    s_lshl_b32 s39, s39, 3
    s_add_u32 s61, s39, 13131776
    v_lshlrev_b32 v21, 3, v7
    s_waitcnt lgkmcnt(0)
    s_mov_b32 s20, s46
    s_and_b32 s21, s47, 0xffff
    s_mov_b32 s22, 14680064
    s_mov_b32 s23, 0x00020000
    s_mov_b32 s24, s44
    s_and_b32 s25, s45, 0xffff
    s_mov_b32 s26, 256
    s_mov_b32 s27, 0x00020000
    s_lshl_b32 s35, s29, 5
    s_lshl_b32 s36, s31, 3
    s_add_u32 s35, s35, s36
    s_lshl_b32 s36, s34, 2
    s_add_u32 s35, s35, s36
    s_lshl_b32 s35, s35, 6
    s_lshl_b32 s36, s30, 2
    s_add_u32 s35, s35, s36
    s_lshl_b32 s36, s33, 1
    s_add_u32 s35, s35, s36
    s_lshl_b32 s35, s35, 10
    s_add_u32 s40, s35, 0
    s_add_u32 s41, s35, 65536
    s_add_u32 s42, s35, 131072
    s_add_u32 s43, s35, 196608
    s_barrier
    ds_read_b128 v[96:99], v8 offset:0
    ds_read_b128 v[112:115], v10 offset:0
    ds_read_b128 v[100:103], v8 offset:512
    ds_read_b128 v[116:119], v10 offset:512
    ds_read_b128 v[104:107], v8 offset:4096
    ds_read_b128 v[120:123], v10 offset:4096
    ds_read_b128 v[108:111], v8 offset:4608
    ds_read_b128 v[124:127], v10 offset:4608
    s_waitcnt lgkmcnt(0)
    v_mfma_f32_16x16x32_bf16 v[32:35], v[96:99], v[112:115], v[32:35]
    ds_read_b128 v[128:131], v9 offset:0
    v_mfma_f32_16x16x32_bf16 v[36:39], v[96:99], v[116:119], v[36:39]
    ds_read_b128 v[144:147], v11 offset:0
    v_mfma_f32_16x16x32_bf16 v[40:43], v[96:99], v[120:123], v[40:43]
    ds_read_b128 v[132:135], v9 offset:512
    v_mfma_f32_16x16x32_bf16 v[44:47], v[96:99], v[124:127], v[44:47]
    ds_read_b128 v[148:151], v11 offset:512
    v_mfma_f32_16x16x32_bf16 v[48:51], v[100:103], v[112:115], v[48:51]
    ds_read_b128 v[136:139], v9 offset:4096
    v_mfma_f32_16x16x32_bf16 v[52:55], v[100:103], v[116:119], v[52:55]
    ds_read_b128 v[152:155], v11 offset:4096
    v_mfma_f32_16x16x32_bf16 v[56:59], v[100:103], v[120:123], v[56:59]
    ds_read_b128 v[140:143], v9 offset:4608
    v_mfma_f32_16x16x32_bf16 v[60:63], v[100:103], v[124:127], v[60:63]
    ds_read_b128 v[156:159], v11 offset:4608
    v_mfma_f32_16x16x32_bf16 v[64:67], v[104:107], v[112:115], v[64:67]
    v_mfma_f32_16x16x32_bf16 v[68:71], v[104:107], v[116:119], v[68:71]
    v_mfma_f32_16x16x32_bf16 v[72:75], v[104:107], v[120:123], v[72:75]
    v_mfma_f32_16x16x32_bf16 v[76:79], v[104:107], v[124:127], v[76:79]
    v_mfma_f32_16x16x32_bf16 v[80:83], v[108:111], v[112:115], v[80:83]
    v_mfma_f32_16x16x32_bf16 v[84:87], v[108:111], v[116:119], v[84:87]
    v_mfma_f32_16x16x32_bf16 v[88:91], v[108:111], v[120:123], v[88:91]
    v_mfma_f32_16x16x32_bf16 v[92:95], v[108:111], v[124:127], v[92:95]
    s_waitcnt lgkmcnt(0)
    v_mfma_f32_16x16x32_bf16 v[32:35], v[128:131], v[144:147], v[32:35]
    s_barrier
    ds_read_b128 v[96:99], v8 offset:32768
    v_mfma_f32_16x16x32_bf16 v[36:39], v[128:131], v[148:151], v[36:39]
    ds_read_b128 v[112:115], v10 offset:32768
    v_mfma_f32_16x16x32_bf16 v[40:43], v[128:131], v[152:155], v[40:43]
    ds_read_b128 v[100:103], v8 offset:33280
    v_mfma_f32_16x16x32_bf16 v[44:47], v[128:131], v[156:159], v[44:47]
    ds_read_b128 v[116:119], v10 offset:33280
    v_mfma_f32_16x16x32_bf16 v[48:51], v[132:135], v[144:147], v[48:51]
    ds_read_b128 v[104:107], v8 offset:36864
    v_mfma_f32_16x16x32_bf16 v[52:55], v[132:135], v[148:151], v[52:55]
    ds_read_b128 v[120:123], v10 offset:36864
    v_mfma_f32_16x16x32_bf16 v[56:59], v[132:135], v[152:155], v[56:59]
    ds_read_b128 v[108:111], v8 offset:37376
    v_mfma_f32_16x16x32_bf16 v[60:63], v[132:135], v[156:159], v[60:63]
    ds_read_b128 v[124:127], v10 offset:37376
    v_mfma_f32_16x16x32_bf16 v[64:67], v[136:139], v[144:147], v[64:67]
    v_mfma_f32_16x16x32_bf16 v[68:71], v[136:139], v[148:151], v[68:71]
    v_mfma_f32_16x16x32_bf16 v[72:75], v[136:139], v[152:155], v[72:75]
    v_mfma_f32_16x16x32_bf16 v[76:79], v[136:139], v[156:159], v[76:79]
    v_mfma_f32_16x16x32_bf16 v[80:83], v[140:143], v[144:147], v[80:83]
    v_mfma_f32_16x16x32_bf16 v[84:87], v[140:143], v[148:151], v[84:87]
    v_mfma_f32_16x16x32_bf16 v[88:91], v[140:143], v[152:155], v[88:91]
    v_mfma_f32_16x16x32_bf16 v[92:95], v[140:143], v[156:159], v[92:95]
    s_waitcnt lgkmcnt(0)
    v_mfma_f32_16x16x32_bf16 v[32:35], v[96:99], v[112:115], v[32:35]
    ds_read_b128 v[128:131], v9 offset:32768
    v_mfma_f32_16x16x32_bf16 v[36:39], v[96:99], v[116:119], v[36:39]
    ds_read_b128 v[144:147], v11 offset:32768
    v_mfma_f32_16x16x32_bf16 v[40:43], v[96:99], v[120:123], v[40:43]
    ds_read_b128 v[132:135], v9 offset:33280
    v_mfma_f32_16x16x32_bf16 v[44:47], v[96:99], v[124:127], v[44:47]
    ds_read_b128 v[148:151], v11 offset:33280
    v_mfma_f32_16x16x32_bf16 v[48:51], v[100:103], v[112:115], v[48:51]
    ds_read_b128 v[136:139], v9 offset:36864
    v_mfma_f32_16x16x32_bf16 v[52:55], v[100:103], v[116:119], v[52:55]
    ds_read_b128 v[152:155], v11 offset:36864
    v_mfma_f32_16x16x32_bf16 v[56:59], v[100:103], v[120:123], v[56:59]
    ds_read_b128 v[140:143], v9 offset:37376
    v_mfma_f32_16x16x32_bf16 v[60:63], v[100:103], v[124:127], v[60:63]
    ds_read_b128 v[156:159], v11 offset:37376
    v_mfma_f32_16x16x32_bf16 v[64:67], v[104:107], v[112:115], v[64:67]
    v_mfma_f32_16x16x32_bf16 v[68:71], v[104:107], v[116:119], v[68:71]
    v_mfma_f32_16x16x32_bf16 v[72:75], v[104:107], v[120:123], v[72:75]
    v_mfma_f32_16x16x32_bf16 v[76:79], v[104:107], v[124:127], v[76:79]
    v_mfma_f32_16x16x32_bf16 v[80:83], v[108:111], v[112:115], v[80:83]
    v_mfma_f32_16x16x32_bf16 v[84:87], v[108:111], v[116:119], v[84:87]
    v_mfma_f32_16x16x32_bf16 v[88:91], v[108:111], v[120:123], v[88:91]
    v_mfma_f32_16x16x32_bf16 v[92:95], v[108:111], v[124:127], v[92:95]
    s_waitcnt lgkmcnt(0)
    v_mfma_f32_16x16x32_bf16 v[32:35], v[128:131], v[144:147], v[32:35]
    s_barrier
    ds_read_b128 v[96:99], v12 offset:0
    v_mfma_f32_16x16x32_bf16 v[36:39], v[128:131], v[148:151], v[36:39]
    ds_read_b128 v[112:115], v14 offset:0
    v_mfma_f32_16x16x32_bf16 v[40:43], v[128:131], v[152:155], v[40:43]
    ds_read_b128 v[100:103], v12 offset:512
    v_mfma_f32_16x16x32_bf16 v[44:47], v[128:131], v[156:159], v[44:47]
    ds_read_b128 v[116:119], v14 offset:512
    v_mfma_f32_16x16x32_bf16 v[48:51], v[132:135], v[144:147], v[48:51]
    ds_read_b128 v[104:107], v12 offset:4096
    v_mfma_f32_16x16x32_bf16 v[52:55], v[132:135], v[148:151], v[52:55]
    ds_read_b128 v[120:123], v14 offset:4096
    v_mfma_f32_16x16x32_bf16 v[56:59], v[132:135], v[152:155], v[56:59]
    ds_read_b128 v[108:111], v12 offset:4608
    v_mfma_f32_16x16x32_bf16 v[60:63], v[132:135], v[156:159], v[60:63]
    ds_read_b128 v[124:127], v14 offset:4608
    v_mfma_f32_16x16x32_bf16 v[64:67], v[136:139], v[144:147], v[64:67]
    v_mfma_f32_16x16x32_bf16 v[68:71], v[136:139], v[148:151], v[68:71]
    v_mfma_f32_16x16x32_bf16 v[72:75], v[136:139], v[152:155], v[72:75]
    v_mfma_f32_16x16x32_bf16 v[76:79], v[136:139], v[156:159], v[76:79]
    v_mfma_f32_16x16x32_bf16 v[80:83], v[140:143], v[144:147], v[80:83]
    v_mfma_f32_16x16x32_bf16 v[84:87], v[140:143], v[148:151], v[84:87]
    v_mfma_f32_16x16x32_bf16 v[88:91], v[140:143], v[152:155], v[88:91]
    v_mfma_f32_16x16x32_bf16 v[92:95], v[140:143], v[156:159], v[92:95]
    s_waitcnt lgkmcnt(0)
    v_mfma_f32_16x16x32_bf16 v[32:35], v[96:99], v[112:115], v[32:35]
    ds_read_b128 v[128:131], v13 offset:0
    v_mfma_f32_16x16x32_bf16 v[36:39], v[96:99], v[116:119], v[36:39]
    ds_read_b128 v[144:147], v15 offset:0
    v_mfma_f32_16x16x32_bf16 v[40:43], v[96:99], v[120:123], v[40:43]
    ds_read_b128 v[132:135], v13 offset:512
    v_mfma_f32_16x16x32_bf16 v[44:47], v[96:99], v[124:127], v[44:47]
    ds_read_b128 v[148:151], v15 offset:512
    v_mfma_f32_16x16x32_bf16 v[48:51], v[100:103], v[112:115], v[48:51]
    ds_read_b128 v[136:139], v13 offset:4096
    v_mfma_f32_16x16x32_bf16 v[52:55], v[100:103], v[116:119], v[52:55]
    ds_read_b128 v[152:155], v15 offset:4096
    v_mfma_f32_16x16x32_bf16 v[56:59], v[100:103], v[120:123], v[56:59]
    ds_read_b128 v[140:143], v13 offset:4608
    v_mfma_f32_16x16x32_bf16 v[60:63], v[100:103], v[124:127], v[60:63]
    ds_read_b128 v[156:159], v15 offset:4608
    v_mfma_f32_16x16x32_bf16 v[64:67], v[104:107], v[112:115], v[64:67]
    v_mfma_f32_16x16x32_bf16 v[68:71], v[104:107], v[116:119], v[68:71]
    v_mfma_f32_16x16x32_bf16 v[72:75], v[104:107], v[120:123], v[72:75]
    v_mfma_f32_16x16x32_bf16 v[76:79], v[104:107], v[124:127], v[76:79]
    v_mfma_f32_16x16x32_bf16 v[80:83], v[108:111], v[112:115], v[80:83]
    v_mfma_f32_16x16x32_bf16 v[84:87], v[108:111], v[116:119], v[84:87]
    v_mfma_f32_16x16x32_bf16 v[88:91], v[108:111], v[120:123], v[88:91]
    v_mfma_f32_16x16x32_bf16 v[92:95], v[108:111], v[124:127], v[92:95]
    s_waitcnt lgkmcnt(0)
    v_mfma_f32_16x16x32_bf16 v[32:35], v[128:131], v[144:147], v[32:35]
    s_barrier
    ds_read_b128 v[96:99], v12 offset:32768
    v_mfma_f32_16x16x32_bf16 v[36:39], v[128:131], v[148:151], v[36:39]
    ds_read_b128 v[112:115], v14 offset:32768
    v_mfma_f32_16x16x32_bf16 v[40:43], v[128:131], v[152:155], v[40:43]
    ds_read_b128 v[100:103], v12 offset:33280
    v_mfma_f32_16x16x32_bf16 v[44:47], v[128:131], v[156:159], v[44:47]
    ds_read_b128 v[116:119], v14 offset:33280
    v_mfma_f32_16x16x32_bf16 v[48:51], v[132:135], v[144:147], v[48:51]
    ds_read_b128 v[104:107], v12 offset:36864
    v_mfma_f32_16x16x32_bf16 v[52:55], v[132:135], v[148:151], v[52:55]
    ds_read_b128 v[120:123], v14 offset:36864
    v_mfma_f32_16x16x32_bf16 v[56:59], v[132:135], v[152:155], v[56:59]
    ds_read_b128 v[108:111], v12 offset:37376
    v_mfma_f32_16x16x32_bf16 v[60:63], v[132:135], v[156:159], v[60:63]
    ds_read_b128 v[124:127], v14 offset:37376
    v_mfma_f32_16x16x32_bf16 v[64:67], v[136:139], v[144:147], v[64:67]
    v_mfma_f32_16x16x32_bf16 v[68:71], v[136:139], v[148:151], v[68:71]
    v_mfma_f32_16x16x32_bf16 v[72:75], v[136:139], v[152:155], v[72:75]
    v_mfma_f32_16x16x32_bf16 v[76:79], v[136:139], v[156:159], v[76:79]
    v_mfma_f32_16x16x32_bf16 v[80:83], v[140:143], v[144:147], v[80:83]
    v_mfma_f32_16x16x32_bf16 v[84:87], v[140:143], v[148:151], v[84:87]
    v_mfma_f32_16x16x32_bf16 v[88:91], v[140:143], v[152:155], v[88:91]
    v_mfma_f32_16x16x32_bf16 v[92:95], v[140:143], v[156:159], v[92:95]
    s_waitcnt lgkmcnt(0)
    v_mfma_f32_16x16x32_bf16 v[32:35], v[96:99], v[112:115], v[32:35]
    ds_read_b128 v[128:131], v13 offset:32768
    v_mfma_f32_16x16x32_bf16 v[36:39], v[96:99], v[116:119], v[36:39]
    ds_read_b128 v[144:147], v15 offset:32768
    v_mfma_f32_16x16x32_bf16 v[40:43], v[96:99], v[120:123], v[40:43]
    ds_read_b128 v[132:135], v13 offset:33280
    v_mfma_f32_16x16x32_bf16 v[44:47], v[96:99], v[124:127], v[44:47]
    ds_read_b128 v[148:151], v15 offset:33280
    v_mfma_f32_16x16x32_bf16 v[48:51], v[100:103], v[112:115], v[48:51]
    ds_read_b128 v[136:139], v13 offset:36864
    v_mfma_f32_16x16x32_bf16 v[52:55], v[100:103], v[116:119], v[52:55]
    ds_read_b128 v[152:155], v15 offset:36864
    v_mfma_f32_16x16x32_bf16 v[56:59], v[100:103], v[120:123], v[56:59]
    ds_read_b128 v[140:143], v13 offset:37376
    v_mfma_f32_16x16x32_bf16 v[60:63], v[100:103], v[124:127], v[60:63]
    ds_read_b128 v[156:159], v15 offset:37376
    v_mfma_f32_16x16x32_bf16 v[64:67], v[104:107], v[112:115], v[64:67]
    v_mfma_f32_16x16x32_bf16 v[68:71], v[104:107], v[116:119], v[68:71]
    v_mfma_f32_16x16x32_bf16 v[72:75], v[104:107], v[120:123], v[72:75]
    v_mfma_f32_16x16x32_bf16 v[76:79], v[104:107], v[124:127], v[76:79]
    v_mfma_f32_16x16x32_bf16 v[80:83], v[108:111], v[112:115], v[80:83]
    v_mfma_f32_16x16x32_bf16 v[84:87], v[108:111], v[116:119], v[84:87]
    v_mfma_f32_16x16x32_bf16 v[88:91], v[108:111], v[120:123], v[88:91]
    v_mfma_f32_16x16x32_bf16 v[92:95], v[108:111], v[124:127], v[92:95]
    s_waitcnt lgkmcnt(0)
    v_mfma_f32_16x16x32_bf16 v[32:35], v[128:131], v[144:147], v[32:35]
    s_barrier
    ds_read_b128 v[96:99], v16 offset:0
    v_mfma_f32_16x16x32_bf16 v[36:39], v[128:131], v[148:151], v[36:39]
    ds_read_b128 v[112:115], v18 offset:0
    v_mfma_f32_16x16x32_bf16 v[40:43], v[128:131], v[152:155], v[40:43]
    ds_read_b128 v[100:103], v16 offset:512
    v_mfma_f32_16x16x32_bf16 v[44:47], v[128:131], v[156:159], v[44:47]
    ds_read_b128 v[116:119], v18 offset:512
    v_mfma_f32_16x16x32_bf16 v[48:51], v[132:135], v[144:147], v[48:51]
    ds_read_b128 v[104:107], v16 offset:4096
    v_mfma_f32_16x16x32_bf16 v[52:55], v[132:135], v[148:151], v[52:55]
    ds_read_b128 v[120:123], v18 offset:4096
    v_mfma_f32_16x16x32_bf16 v[56:59], v[132:135], v[152:155], v[56:59]
    ds_read_b128 v[108:111], v16 offset:4608
    v_mfma_f32_16x16x32_bf16 v[60:63], v[132:135], v[156:159], v[60:63]
    ds_read_b128 v[124:127], v18 offset:4608
    v_mfma_f32_16x16x32_bf16 v[64:67], v[136:139], v[144:147], v[64:67]
    v_mfma_f32_16x16x32_bf16 v[68:71], v[136:139], v[148:151], v[68:71]
    v_mfma_f32_16x16x32_bf16 v[72:75], v[136:139], v[152:155], v[72:75]
    v_mfma_f32_16x16x32_bf16 v[76:79], v[136:139], v[156:159], v[76:79]
    v_mfma_f32_16x16x32_bf16 v[80:83], v[140:143], v[144:147], v[80:83]
    v_mfma_f32_16x16x32_bf16 v[84:87], v[140:143], v[148:151], v[84:87]
    v_mfma_f32_16x16x32_bf16 v[88:91], v[140:143], v[152:155], v[88:91]
    v_mfma_f32_16x16x32_bf16 v[92:95], v[140:143], v[156:159], v[92:95]
    s_waitcnt lgkmcnt(0)
    v_mfma_f32_16x16x32_bf16 v[32:35], v[96:99], v[112:115], v[32:35]
    ds_read_b128 v[128:131], v17 offset:0
    v_mfma_f32_16x16x32_bf16 v[36:39], v[96:99], v[116:119], v[36:39]
    ds_read_b128 v[144:147], v19 offset:0
    v_mfma_f32_16x16x32_bf16 v[40:43], v[96:99], v[120:123], v[40:43]
    ds_read_b128 v[132:135], v17 offset:512
    v_mfma_f32_16x16x32_bf16 v[44:47], v[96:99], v[124:127], v[44:47]
    ds_read_b128 v[148:151], v19 offset:512
    v_mfma_f32_16x16x32_bf16 v[48:51], v[100:103], v[112:115], v[48:51]
    ds_read_b128 v[136:139], v17 offset:4096
    v_mfma_f32_16x16x32_bf16 v[52:55], v[100:103], v[116:119], v[52:55]
    ds_read_b128 v[152:155], v19 offset:4096
    v_mfma_f32_16x16x32_bf16 v[56:59], v[100:103], v[120:123], v[56:59]
    ds_read_b128 v[140:143], v17 offset:4608
    v_mfma_f32_16x16x32_bf16 v[60:63], v[100:103], v[124:127], v[60:63]
    ds_read_b128 v[156:159], v19 offset:4608
    v_mfma_f32_16x16x32_bf16 v[64:67], v[104:107], v[112:115], v[64:67]
    v_mfma_f32_16x16x32_bf16 v[68:71], v[104:107], v[116:119], v[68:71]
    v_mfma_f32_16x16x32_bf16 v[72:75], v[104:107], v[120:123], v[72:75]
    v_mfma_f32_16x16x32_bf16 v[76:79], v[104:107], v[124:127], v[76:79]
    v_mfma_f32_16x16x32_bf16 v[80:83], v[108:111], v[112:115], v[80:83]
    v_mfma_f32_16x16x32_bf16 v[84:87], v[108:111], v[116:119], v[84:87]
    v_mfma_f32_16x16x32_bf16 v[88:91], v[108:111], v[120:123], v[88:91]
    v_mfma_f32_16x16x32_bf16 v[92:95], v[108:111], v[124:127], v[92:95]
    s_waitcnt lgkmcnt(0)
    v_mfma_f32_16x16x32_bf16 v[32:35], v[128:131], v[144:147], v[32:35]
    s_barrier
    ds_read_b128 v[96:99], v8 offset:0
    v_mfma_f32_16x16x32_bf16 v[36:39], v[128:131], v[148:151], v[36:39]
    ds_read_b128 v[112:115], v10 offset:0
    v_mfma_f32_16x16x32_bf16 v[40:43], v[128:131], v[152:155], v[40:43]
    ds_read_b128 v[100:103], v8 offset:512
    v_mfma_f32_16x16x32_bf16 v[44:47], v[128:131], v[156:159], v[44:47]
    ds_read_b128 v[116:119], v10 offset:512
    v_mfma_f32_16x16x32_bf16 v[48:51], v[132:135], v[144:147], v[48:51]
    ds_read_b128 v[104:107], v8 offset:4096
    v_mfma_f32_16x16x32_bf16 v[52:55], v[132:135], v[148:151], v[52:55]
    ds_read_b128 v[120:123], v10 offset:4096
    v_mfma_f32_16x16x32_bf16 v[56:59], v[132:135], v[152:155], v[56:59]
    ds_read_b128 v[108:111], v8 offset:4608
    v_mfma_f32_16x16x32_bf16 v[60:63], v[132:135], v[156:159], v[60:63]
    ds_read_b128 v[124:127], v10 offset:4608
    v_mfma_f32_16x16x32_bf16 v[64:67], v[136:139], v[144:147], v[64:67]
    v_mfma_f32_16x16x32_bf16 v[68:71], v[136:139], v[148:151], v[68:71]
    v_mfma_f32_16x16x32_bf16 v[72:75], v[136:139], v[152:155], v[72:75]
    v_mfma_f32_16x16x32_bf16 v[76:79], v[136:139], v[156:159], v[76:79]
    v_mfma_f32_16x16x32_bf16 v[80:83], v[140:143], v[144:147], v[80:83]
    v_mfma_f32_16x16x32_bf16 v[84:87], v[140:143], v[148:151], v[84:87]
    v_mfma_f32_16x16x32_bf16 v[88:91], v[140:143], v[152:155], v[88:91]
    v_mfma_f32_16x16x32_bf16 v[92:95], v[140:143], v[156:159], v[92:95]
    s_waitcnt lgkmcnt(0)
    v_mfma_f32_16x16x32_bf16 v[32:35], v[96:99], v[112:115], v[32:35]
    ds_read_b128 v[128:131], v9 offset:0
    v_mfma_f32_16x16x32_bf16 v[36:39], v[96:99], v[116:119], v[36:39]
    ds_read_b128 v[144:147], v11 offset:0
    v_mfma_f32_16x16x32_bf16 v[40:43], v[96:99], v[120:123], v[40:43]
    ds_read_b128 v[132:135], v9 offset:512
    v_mfma_f32_16x16x32_bf16 v[44:47], v[96:99], v[124:127], v[44:47]
    ds_read_b128 v[148:151], v11 offset:512
    v_mfma_f32_16x16x32_bf16 v[48:51], v[100:103], v[112:115], v[48:51]
    ds_read_b128 v[136:139], v9 offset:4096
    v_mfma_f32_16x16x32_bf16 v[52:55], v[100:103], v[116:119], v[52:55]
    ds_read_b128 v[152:155], v11 offset:4096
    v_mfma_f32_16x16x32_bf16 v[56:59], v[100:103], v[120:123], v[56:59]
    ds_read_b128 v[140:143], v9 offset:4608
    v_mfma_f32_16x16x32_bf16 v[60:63], v[100:103], v[124:127], v[60:63]
    ds_read_b128 v[156:159], v11 offset:4608
    v_mfma_f32_16x16x32_bf16 v[64:67], v[104:107], v[112:115], v[64:67]
    v_mfma_f32_16x16x32_bf16 v[68:71], v[104:107], v[116:119], v[68:71]
    buffer_load_dwordx4 v[160:163], v23, s[20:23], s38 offen offset:0 sc1
    buffer_load_dwordx4 v[164:167], v23, s[20:23], s38 offen offset:16 sc1
    buffer_load_dwordx4 v[168:171], v23, s[20:23], s38 offen offset:32 sc1
    buffer_load_dwordx4 v[172:175], v23, s[20:23], s38 offen offset:48 sc1
    buffer_load_dwordx4 v[176:179], v23, s[20:23], s38 offen offset:256 sc1
    buffer_load_dwordx4 v[180:183], v23, s[20:23], s38 offen offset:272 sc1
    buffer_load_dwordx4 v[184:187], v23, s[20:23], s38 offen offset:288 sc1
    buffer_load_dwordx4 v[188:191], v23, s[20:23], s38 offen offset:304 sc1
    buffer_load_dwordx2 v[192:193], v21, s[20:23], s61 offen offset:0 sc1
    buffer_load_dwordx2 v[194:195], v21, s[20:23], s61 offen offset:32 sc1
    buffer_load_dwordx2 v[196:197], v21, s[20:23], s61 offen offset:256 sc1
    buffer_load_dwordx2 v[198:199], v21, s[20:23], s61 offen offset:288 sc1
    buffer_load_dword v25, v24, s[24:27], 0 offen sc1
    v_mfma_f32_16x16x32_bf16 v[72:75], v[104:107], v[120:123], v[72:75]
    v_mfma_f32_16x16x32_bf16 v[76:79], v[104:107], v[124:127], v[76:79]
    v_mfma_f32_16x16x32_bf16 v[80:83], v[108:111], v[112:115], v[80:83]
    v_mfma_f32_16x16x32_bf16 v[84:87], v[108:111], v[116:119], v[84:87]
    v_mfma_f32_16x16x32_bf16 v[88:91], v[108:111], v[120:123], v[88:91]
    v_mfma_f32_16x16x32_bf16 v[92:95], v[108:111], v[124:127], v[92:95]
    s_waitcnt lgkmcnt(0)
    v_mfma_f32_16x16x32_bf16 v[32:35], v[128:131], v[144:147], v[32:35]
    s_barrier
    ds_read_b128 v[96:99], v8 offset:32768
    v_mfma_f32_16x16x32_bf16 v[36:39], v[128:131], v[148:151], v[36:39]
    ds_read_b128 v[112:115], v10 offset:32768
    v_mfma_f32_16x16x32_bf16 v[40:43], v[128:131], v[152:155], v[40:43]
    ds_read_b128 v[100:103], v8 offset:33280
    v_mfma_f32_16x16x32_bf16 v[44:47], v[128:131], v[156:159], v[44:47]
    ds_read_b128 v[116:119], v10 offset:33280
    v_mfma_f32_16x16x32_bf16 v[48:51], v[132:135], v[144:147], v[48:51]
    ds_read_b128 v[104:107], v8 offset:36864
    v_mfma_f32_16x16x32_bf16 v[52:55], v[132:135], v[148:151], v[52:55]
    ds_read_b128 v[120:123], v10 offset:36864
    v_mfma_f32_16x16x32_bf16 v[56:59], v[132:135], v[152:155], v[56:59]
    ds_read_b128 v[108:111], v8 offset:37376
    v_mfma_f32_16x16x32_bf16 v[60:63], v[132:135], v[156:159], v[60:63]
    ds_read_b128 v[124:127], v10 offset:37376
    v_mfma_f32_16x16x32_bf16 v[64:67], v[136:139], v[144:147], v[64:67]
    v_mfma_f32_16x16x32_bf16 v[68:71], v[136:139], v[148:151], v[68:71]
    v_mfma_f32_16x16x32_bf16 v[72:75], v[136:139], v[152:155], v[72:75]
    v_mfma_f32_16x16x32_bf16 v[76:79], v[136:139], v[156:159], v[76:79]
    v_mfma_f32_16x16x32_bf16 v[80:83], v[140:143], v[144:147], v[80:83]
    v_mfma_f32_16x16x32_bf16 v[84:87], v[140:143], v[148:151], v[84:87]
    v_mfma_f32_16x16x32_bf16 v[88:91], v[140:143], v[152:155], v[88:91]
    v_mfma_f32_16x16x32_bf16 v[92:95], v[140:143], v[156:159], v[92:95]
    s_waitcnt lgkmcnt(0)
    v_mfma_f32_16x16x32_bf16 v[32:35], v[96:99], v[112:115], v[32:35]
    ds_read_b128 v[128:131], v9 offset:32768
    v_mfma_f32_16x16x32_bf16 v[36:39], v[96:99], v[116:119], v[36:39]
    ds_read_b128 v[144:147], v11 offset:32768
    v_mfma_f32_16x16x32_bf16 v[40:43], v[96:99], v[120:123], v[40:43]
    ds_read_b128 v[132:135], v9 offset:33280
    v_mfma_f32_16x16x32_bf16 v[44:47], v[96:99], v[124:127], v[44:47]
    ds_read_b128 v[148:151], v11 offset:33280
    v_mfma_f32_16x16x32_bf16 v[48:51], v[100:103], v[112:115], v[48:51]
    ds_read_b128 v[136:139], v9 offset:36864
    v_mfma_f32_16x16x32_bf16 v[52:55], v[100:103], v[116:119], v[52:55]
    ds_read_b128 v[152:155], v11 offset:36864
    v_mfma_f32_16x16x32_bf16 v[56:59], v[100:103], v[120:123], v[56:59]
    ds_read_b128 v[140:143], v9 offset:37376
    v_mfma_f32_16x16x32_bf16 v[60:63], v[100:103], v[124:127], v[60:63]
    ds_read_b128 v[156:159], v11 offset:37376
    v_mfma_f32_16x16x32_bf16 v[64:67], v[104:107], v[112:115], v[64:67]
    v_mfma_f32_16x16x32_bf16 v[68:71], v[104:107], v[116:119], v[68:71]
    v_mfma_f32_16x16x32_bf16 v[72:75], v[104:107], v[120:123], v[72:75]
    v_mfma_f32_16x16x32_bf16 v[76:79], v[104:107], v[124:127], v[76:79]
    v_mfma_f32_16x16x32_bf16 v[80:83], v[108:111], v[112:115], v[80:83]
    v_mfma_f32_16x16x32_bf16 v[84:87], v[108:111], v[116:119], v[84:87]
    v_mfma_f32_16x16x32_bf16 v[88:91], v[108:111], v[120:123], v[88:91]
    v_mfma_f32_16x16x32_bf16 v[92:95], v[108:111], v[124:127], v[92:95]
    s_waitcnt lgkmcnt(0)
    s_waitcnt vmcnt(0)
    v_mfma_f32_16x16x32_bf16 v[32:35], v[128:131], v[144:147], v[32:35]
    s_barrier
    ds_read_b128 v[96:99], v12 offset:0
    v_xor_b32 v26, v25, v161
    v_xor_b32 v27, v25, v163
    v_mfma_f32_16x16x32_bf16 v[36:39], v[128:131], v[148:151], v[36:39]
    ds_read_b128 v[112:115], v14 offset:0
    v_or_b32 v26, v26, v27
    v_xor_b32 v27, v25, v165
    v_mfma_f32_16x16x32_bf16 v[40:43], v[128:131], v[152:155], v[40:43]
    ds_read_b128 v[100:103], v12 offset:512
    v_or_b32 v26, v26, v27
    v_xor_b32 v27, v25, v167
    v_mfma_f32_16x16x32_bf16 v[44:47], v[128:131], v[156:159], v[44:47]
    ds_read_b128 v[116:119], v14 offset:512
    v_or_b32 v26, v26, v27
    v_xor_b32 v27, v25, v169
    v_mfma_f32_16x16x32_bf16 v[48:51], v[132:135], v[144:147], v[48:51]
    ds_read_b128 v[104:107], v12 offset:4096
    v_or_b32 v26, v26, v27
    v_xor_b32 v27, v25, v171
    v_mfma_f32_16x16x32_bf16 v[52:55], v[132:135], v[148:151], v[52:55]
    ds_read_b128 v[120:123], v14 offset:4096
    v_or_b32 v26, v26, v27
    v_xor_b32 v27, v25, v173
    v_mfma_f32_16x16x32_bf16 v[56:59], v[132:135], v[152:155], v[56:59]
    ds_read_b128 v[108:111], v12 offset:4608
    v_or_b32 v26, v26, v27
    v_xor_b32 v27, v25, v175
    v_mfma_f32_16x16x32_bf16 v[60:63], v[132:135], v[156:159], v[60:63]
    ds_read_b128 v[124:127], v14 offset:4608
    v_or_b32 v26, v26, v27
    v_xor_b32 v27, v25, v177
    v_mfma_f32_16x16x32_bf16 v[64:67], v[136:139], v[144:147], v[64:67]
    v_or_b32 v26, v26, v27
    v_xor_b32 v27, v25, v179
    v_mfma_f32_16x16x32_bf16 v[68:71], v[136:139], v[148:151], v[68:71]
    v_or_b32 v26, v26, v27
    v_xor_b32 v27, v25, v181
    v_mfma_f32_16x16x32_bf16 v[72:75], v[136:139], v[152:155], v[72:75]
    v_or_b32 v26, v26, v27
    v_xor_b32 v27, v25, v183
    v_mfma_f32_16x16x32_bf16 v[76:79], v[136:139], v[156:159], v[76:79]
    v_or_b32 v26, v26, v27
    v_xor_b32 v27, v25, v185
    v_mfma_f32_16x16x32_bf16 v[80:83], v[140:143], v[144:147], v[80:83]
    v_or_b32 v26, v26, v27
    v_xor_b32 v27, v25, v187
    v_mfma_f32_16x16x32_bf16 v[84:87], v[140:143], v[148:151], v[84:87]
    v_or_b32 v26, v26, v27
    v_xor_b32 v27, v25, v189
    v_mfma_f32_16x16x32_bf16 v[88:91], v[140:143], v[152:155], v[88:91]
    v_or_b32 v26, v26, v27
    v_xor_b32 v27, v25, v191
    v_mfma_f32_16x16x32_bf16 v[92:95], v[140:143], v[156:159], v[92:95]
    v_or_b32 v26, v26, v27
    v_xor_b32 v27, v25, v193
    s_waitcnt lgkmcnt(0)
    v_mfma_f32_16x16x32_bf16 v[32:35], v[96:99], v[112:115], v[32:35]
    ds_read_b128 v[128:131], v13 offset:0
    v_or_b32 v26, v26, v27
    v_xor_b32 v27, v25, v195
    v_mfma_f32_16x16x32_bf16 v[36:39], v[96:99], v[116:119], v[36:39]
    ds_read_b128 v[144:147], v15 offset:0
    v_or_b32 v26, v26, v27
    v_xor_b32 v27, v25, v197
    v_mfma_f32_16x16x32_bf16 v[40:43], v[96:99], v[120:123], v[40:43]
    ds_read_b128 v[132:135], v13 offset:512
    v_or_b32 v26, v26, v27
    v_xor_b32 v27, v25, v199
    v_mfma_f32_16x16x32_bf16 v[44:47], v[96:99], v[124:127], v[44:47]
    ds_read_b128 v[148:151], v15 offset:512
    v_or_b32 v26, v26, v27
    v_lshlrev_b32 v161, 16, v160
    v_mfma_f32_16x16x32_bf16 v[48:51], v[100:103], v[112:115], v[48:51]
    ds_read_b128 v[136:139], v13 offset:4096
    v_rcp_f32 v161, v161
    v_and_b32 v160, s53, v160
    v_mfma_f32_16x16x32_bf16 v[52:55], v[100:103], v[116:119], v[52:55]
    ds_read_b128 v[152:155], v15 offset:4096
    v_lshlrev_b32 v163, 16, v162
    v_rcp_f32 v163, v163
    v_mfma_f32_16x16x32_bf16 v[56:59], v[100:103], v[120:123], v[56:59]
    ds_read_b128 v[140:143], v13 offset:4608
    v_and_b32 v162, s53, v162
    v_lshlrev_b32 v165, 16, v164
    v_mfma_f32_16x16x32_bf16 v[60:63], v[100:103], v[124:127], v[60:63]
    ds_read_b128 v[156:159], v15 offset:4608
    v_rcp_f32 v165, v165
    v_and_b32 v164, s53, v164
    v_mfma_f32_16x16x32_bf16 v[64:67], v[104:107], v[112:115], v[64:67]
    v_lshlrev_b32 v167, 16, v166
    v_rcp_f32 v167, v167
    v_mfma_f32_16x16x32_bf16 v[68:71], v[104:107], v[116:119], v[68:71]
    v_and_b32 v166, s53, v166
    v_lshlrev_b32 v169, 16, v168
    v_mfma_f32_16x16x32_bf16 v[72:75], v[104:107], v[120:123], v[72:75]
    v_rcp_f32 v169, v169
    v_and_b32 v168, s53, v168
    v_mfma_f32_16x16x32_bf16 v[76:79], v[104:107], v[124:127], v[76:79]
    v_lshlrev_b32 v171, 16, v170
    v_rcp_f32 v171, v171
    v_mfma_f32_16x16x32_bf16 v[80:83], v[108:111], v[112:115], v[80:83]
    v_and_b32 v170, s53, v170
    v_lshlrev_b32 v173, 16, v172
    v_mfma_f32_16x16x32_bf16 v[84:87], v[108:111], v[116:119], v[84:87]
    v_rcp_f32 v173, v173
    v_and_b32 v172, s53, v172
    v_mfma_f32_16x16x32_bf16 v[88:91], v[108:111], v[120:123], v[88:91]
    v_lshlrev_b32 v175, 16, v174
    v_rcp_f32 v175, v175
    v_mfma_f32_16x16x32_bf16 v[92:95], v[108:111], v[124:127], v[92:95]
    v_and_b32 v174, s53, v174
    v_lshlrev_b32 v177, 16, v176
    s_waitcnt lgkmcnt(0)
    v_mfma_f32_16x16x32_bf16 v[32:35], v[128:131], v[144:147], v[32:35]
    v_rcp_f32 v177, v177
    v_and_b32 v176, s53, v176
    v_mfma_f32_16x16x32_bf16 v[36:39], v[128:131], v[148:151], v[36:39]
    v_lshlrev_b32 v179, 16, v178
    v_rcp_f32 v179, v179
    v_mfma_f32_16x16x32_bf16 v[40:43], v[128:131], v[152:155], v[40:43]
    v_and_b32 v178, s53, v178
    v_lshlrev_b32 v181, 16, v180
    v_mfma_f32_16x16x32_bf16 v[44:47], v[128:131], v[156:159], v[44:47]
    v_rcp_f32 v181, v181
    v_and_b32 v180, s53, v180
    v_mfma_f32_16x16x32_bf16 v[48:51], v[132:135], v[144:147], v[48:51]
    v_lshlrev_b32 v183, 16, v182
    v_rcp_f32 v183, v183
    v_mfma_f32_16x16x32_bf16 v[52:55], v[132:135], v[148:151], v[52:55]
    v_and_b32 v182, s53, v182
    v_lshlrev_b32 v185, 16, v184
    v_mfma_f32_16x16x32_bf16 v[56:59], v[132:135], v[152:155], v[56:59]
    v_rcp_f32 v185, v185
    v_and_b32 v184, s53, v184
    v_mfma_f32_16x16x32_bf16 v[60:63], v[132:135], v[156:159], v[60:63]
    v_lshlrev_b32 v187, 16, v186
    v_rcp_f32 v187, v187
    v_mfma_f32_16x16x32_bf16 v[64:67], v[136:139], v[144:147], v[64:67]
    v_and_b32 v186, s53, v186
    v_lshlrev_b32 v189, 16, v188
    v_mfma_f32_16x16x32_bf16 v[68:71], v[136:139], v[148:151], v[68:71]
    v_rcp_f32 v189, v189
    v_and_b32 v188, s53, v188
    v_mfma_f32_16x16x32_bf16 v[72:75], v[136:139], v[152:155], v[72:75]
    v_lshlrev_b32 v191, 16, v190
    v_rcp_f32 v191, v191
    v_mfma_f32_16x16x32_bf16 v[76:79], v[136:139], v[156:159], v[76:79]
    v_and_b32 v190, s53, v190
    v_mfma_f32_16x16x32_bf16 v[80:83], v[140:143], v[144:147], v[80:83]
    v_mfma_f32_16x16x32_bf16 v[84:87], v[140:143], v[148:151], v[84:87]
    v_mfma_f32_16x16x32_bf16 v[88:91], v[140:143], v[152:155], v[88:91]
    v_mfma_f32_16x16x32_bf16 v[92:95], v[140:143], v[156:159], v[92:95]
k1_kernel_chk:
    v_cmp_eq_u32 vcc, 0, v25
    v_cmp_ne_u32 s[62:63], 0, v26
    s_or_b64 s[62:63], s[62:63], vcc
    s_cbranch_scc0 k1_kernel_have
    s_sleep 4
    buffer_load_dwordx4 v[160:163], v23, s[20:23], s38 offen offset:0 sc1
    buffer_load_dwordx4 v[164:167], v23, s[20:23], s38 offen offset:16 sc1
    buffer_load_dwordx4 v[168:171], v23, s[20:23], s38 offen offset:32 sc1
    buffer_load_dwordx4 v[172:175], v23, s[20:23], s38 offen offset:48 sc1
    buffer_load_dwordx4 v[176:179], v23, s[20:23], s38 offen offset:256 sc1
    buffer_load_dwordx4 v[180:183], v23, s[20:23], s38 offen offset:272 sc1
    buffer_load_dwordx4 v[184:187], v23, s[20:23], s38 offen offset:288 sc1
    buffer_load_dwordx4 v[188:191], v23, s[20:23], s38 offen offset:304 sc1
    buffer_load_dwordx2 v[192:193], v21, s[20:23], s61 offen offset:0 sc1
    buffer_load_dwordx2 v[194:195], v21, s[20:23], s61 offen offset:32 sc1
    buffer_load_dwordx2 v[196:197], v21, s[20:23], s61 offen offset:256 sc1
    buffer_load_dwordx2 v[198:199], v21, s[20:23], s61 offen offset:288 sc1
    buffer_load_dword v25, v24, s[24:27], 0 offen sc1
    s_waitcnt vmcnt(0)
    v_xor_b32 v26, v25, v161
    v_xor_b32 v27, v25, v163
    v_or_b32 v26, v26, v27
    v_xor_b32 v27, v25, v165
    v_or_b32 v26, v26, v27
    v_xor_b32 v27, v25, v167
    v_or_b32 v26, v26, v27
    v_xor_b32 v27, v25, v169
    v_or_b32 v26, v26, v27
    v_xor_b32 v27, v25, v171
    v_or_b32 v26, v26, v27
    v_xor_b32 v27, v25, v173
    v_or_b32 v26, v26, v27
    v_xor_b32 v27, v25, v175
    v_or_b32 v26, v26, v27
    v_xor_b32 v27, v25, v177
    v_or_b32 v26, v26, v27
    v_xor_b32 v27, v25, v179
    v_or_b32 v26, v26, v27
    v_xor_b32 v27, v25, v181
    v_or_b32 v26, v26, v27
    v_xor_b32 v27, v25, v183
    v_or_b32 v26, v26, v27
    v_xor_b32 v27, v25, v185
    v_or_b32 v26, v26, v27
    v_xor_b32 v27, v25, v187
    v_or_b32 v26, v26, v27
    v_xor_b32 v27, v25, v189
    v_or_b32 v26, v26, v27
    v_xor_b32 v27, v25, v191
    v_or_b32 v26, v26, v27
    v_xor_b32 v27, v25, v193
    v_or_b32 v26, v26, v27
    v_xor_b32 v27, v25, v195
    v_or_b32 v26, v26, v27
    v_xor_b32 v27, v25, v197
    v_or_b32 v26, v26, v27
    v_xor_b32 v27, v25, v199
    v_or_b32 v26, v26, v27
    v_lshlrev_b32 v161, 16, v160
    v_rcp_f32 v161, v161
    v_and_b32 v160, s53, v160
    v_lshlrev_b32 v163, 16, v162
    v_rcp_f32 v163, v163
    v_and_b32 v162, s53, v162
    v_lshlrev_b32 v165, 16, v164
    v_rcp_f32 v165, v165
    v_and_b32 v164, s53, v164
    v_lshlrev_b32 v167, 16, v166
    v_rcp_f32 v167, v167
    v_and_b32 v166, s53, v166
    v_lshlrev_b32 v169, 16, v168
    v_rcp_f32 v169, v169
    v_and_b32 v168, s53, v168
    v_lshlrev_b32 v171, 16, v170
    v_rcp_f32 v171, v171
    v_and_b32 v170, s53, v170
    v_lshlrev_b32 v173, 16, v172
    v_rcp_f32 v173, v173
    v_and_b32 v172, s53, v172
    v_lshlrev_b32 v175, 16, v174
    v_rcp_f32 v175, v175
    v_and_b32 v174, s53, v174
    v_lshlrev_b32 v177, 16, v176
    v_rcp_f32 v177, v177
    v_and_b32 v176, s53, v176
    v_lshlrev_b32 v179, 16, v178
    v_rcp_f32 v179, v179
    v_and_b32 v178, s53, v178
    v_lshlrev_b32 v181, 16, v180
    v_rcp_f32 v181, v181
    v_and_b32 v180, s53, v180
    v_lshlrev_b32 v183, 16, v182
    v_rcp_f32 v183, v183
    v_and_b32 v182, s53, v182
    v_lshlrev_b32 v185, 16, v184
    v_rcp_f32 v185, v185
    v_and_b32 v184, s53, v184
    v_lshlrev_b32 v187, 16, v186
    v_rcp_f32 v187, v187
    v_and_b32 v186, s53, v186
    v_lshlrev_b32 v189, 16, v188
    v_rcp_f32 v189, v189
    v_and_b32 v188, s53, v188
    v_lshlrev_b32 v191, 16, v190
    v_rcp_f32 v191, v191
    v_and_b32 v190, s53, v190
    s_sub_u32 s69, s69, 1
    s_cbranch_scc0 k1_kernel_chk
    s_mov_b32 s69, 0
k1_kernel_have:
    v_lshlrev_b32 v22, 4, v2
    s_nop 4
    v_fma_f32 v32, -v160, v192, v32
    v_mul_f32 v32, v32, v161
    v_fma_f32 v33, -v162, v192, v33
    v_mul_f32 v33, v33, v163
    v_fma_f32 v34, -v164, v192, v34
    v_mul_f32 v34, v34, v165
    v_fma_f32 v35, -v166, v192, v35
    v_mul_f32 v35, v35, v167
    v_cvt_pk_bf16_f32 v132, v32, v33
    v_cvt_pk_bf16_f32 v133, v34, v35
    v_fma_f32 v48, -v168, v192, v48
    v_mul_f32 v48, v48, v169
    v_fma_f32 v49, -v170, v192, v49
    v_mul_f32 v49, v49, v171
    v_fma_f32 v50, -v172, v192, v50
    v_mul_f32 v50, v50, v173
    v_fma_f32 v51, -v174, v192, v51
    v_mul_f32 v51, v51, v175
    v_cvt_pk_bf16_f32 v134, v48, v49
    v_cvt_pk_bf16_f32 v135, v50, v51
    buffer_store_dwordx4 v[132:135], v22, s[20:23], s40 offen offset:0 sc0 sc1
    v_fma_f32 v36, -v160, v194, v36
    v_mul_f32 v36, v36, v161
    v_fma_f32 v37, -v162, v194, v37
    v_mul_f32 v37, v37, v163
    v_fma_f32 v38, -v164, v194, v38
    v_mul_f32 v38, v38, v165
    v_fma_f32 v39, -v166, v194, v39
    v_mul_f32 v39, v39, v167
    v_cvt_pk_bf16_f32 v136, v36, v37
    v_cvt_pk_bf16_f32 v137, v38, v39
    v_fma_f32 v52, -v168, v194, v52
    v_mul_f32 v52, v52, v169
    v_fma_f32 v53, -v170, v194, v53
    v_mul_f32 v53, v53, v171
    v_fma_f32 v54, -v172, v194, v54
    v_mul_f32 v54, v54, v173
    v_fma_f32 v55, -v174, v194, v55
    v_mul_f32 v55, v55, v175
    v_cvt_pk_bf16_f32 v138, v52, v53
    v_cvt_pk_bf16_f32 v139, v54, v55
    buffer_store_dwordx4 v[136:139], v22, s[20:23], s41 offen offset:0 sc0 sc1
    v_fma_f32 v40, -v160, v196, v40
    v_mul_f32 v40, v40, v161
    v_fma_f32 v41, -v162, v196, v41
    v_mul_f32 v41, v41, v163
    v_fma_f32 v42, -v164, v196, v42
    v_mul_f32 v42, v42, v165
    v_fma_f32 v43, -v166, v196, v43
    v_mul_f32 v43, v43, v167
    v_cvt_pk_bf16_f32 v140, v40, v41
    v_cvt_pk_bf16_f32 v141, v42, v43
    v_fma_f32 v56, -v168, v196, v56
    v_mul_f32 v56, v56, v169
    v_fma_f32 v57, -v170, v196, v57
    v_mul_f32 v57, v57, v171
    v_fma_f32 v58, -v172, v196, v58
    v_mul_f32 v58, v58, v173
    v_fma_f32 v59, -v174, v196, v59
    v_mul_f32 v59, v59, v175
    v_cvt_pk_bf16_f32 v142, v56, v57
    v_cvt_pk_bf16_f32 v143, v58, v59
    buffer_store_dwordx4 v[140:143], v22, s[20:23], s42 offen offset:0 sc0 sc1
    v_fma_f32 v44, -v160, v198, v44
    v_mul_f32 v44, v44, v161
    v_fma_f32 v45, -v162, v198, v45
    v_mul_f32 v45, v45, v163
    v_fma_f32 v46, -v164, v198, v46
    v_mul_f32 v46, v46, v165
    v_fma_f32 v47, -v166, v198, v47
    v_mul_f32 v47, v47, v167
    v_cvt_pk_bf16_f32 v144, v44, v45
    v_cvt_pk_bf16_f32 v145, v46, v47
    v_fma_f32 v60, -v168, v198, v60
    v_mul_f32 v60, v60, v169
    v_fma_f32 v61, -v170, v198, v61
    v_mul_f32 v61, v61, v171
    v_fma_f32 v62, -v172, v198, v62
    v_mul_f32 v62, v62, v173
    v_fma_f32 v63, -v174, v198, v63
    v_mul_f32 v63, v63, v175
    v_cvt_pk_bf16_f32 v146, v60, v61
    v_cvt_pk_bf16_f32 v147, v62, v63
    buffer_store_dwordx4 v[144:147], v22, s[20:23], s43 offen offset:0 sc0 sc1
    v_fma_f32 v64, -v176, v192, v64
    v_mul_f32 v64, v64, v177
    v_fma_f32 v65, -v178, v192, v65
    v_mul_f32 v65, v65, v179
    v_fma_f32 v66, -v180, v192, v66
    v_mul_f32 v66, v66, v181
    v_fma_f32 v67, -v182, v192, v67
    v_mul_f32 v67, v67, v183
    v_cvt_pk_bf16_f32 v132, v64, v65
    v_cvt_pk_bf16_f32 v133, v66, v67
    v_fma_f32 v80, -v184, v192, v80
    v_mul_f32 v80, v80, v185
    v_fma_f32 v81, -v186, v192, v81
    v_mul_f32 v81, v81, v187
    v_fma_f32 v82, -v188, v192, v82
    v_mul_f32 v82, v82, v189
    v_fma_f32 v83, -v190, v192, v83
    v_mul_f32 v83, v83, v191
    v_cvt_pk_bf16_f32 v134, v80, v81
    v_cvt_pk_bf16_f32 v135, v82, v83
    buffer_store_dwordx4 v[132:135], v22, s[20:23], s40 offen offset:1024 sc0 sc1
    v_fma_f32 v68, -v176, v194, v68
    v_mul_f32 v68, v68, v177
    v_fma_f32 v69, -v178, v194, v69
    v_mul_f32 v69, v69, v179
    v_fma_f32 v70, -v180, v194, v70
    v_mul_f32 v70, v70, v181
    v_fma_f32 v71, -v182, v194, v71
    v_mul_f32 v71, v71, v183
    v_cvt_pk_bf16_f32 v136, v68, v69
    v_cvt_pk_bf16_f32 v137, v70, v71
    v_fma_f32 v84, -v184, v194, v84
    v_mul_f32 v84, v84, v185
    v_fma_f32 v85, -v186, v194, v85
    v_mul_f32 v85, v85, v187
    v_fma_f32 v86, -v188, v194, v86
    v_mul_f32 v86, v86, v189
    v_fma_f32 v87, -v190, v194, v87
    v_mul_f32 v87, v87, v191
    v_cvt_pk_bf16_f32 v138, v84, v85
    v_cvt_pk_bf16_f32 v139, v86, v87
    buffer_store_dwordx4 v[136:139], v22, s[20:23], s41 offen offset:1024 sc0 sc1
    v_fma_f32 v72, -v176, v196, v72
    v_mul_f32 v72, v72, v177
    v_fma_f32 v73, -v178, v196, v73
    v_mul_f32 v73, v73, v179
    v_fma_f32 v74, -v180, v196, v74
    v_mul_f32 v74, v74, v181
    v_fma_f32 v75, -v182, v196, v75
    v_mul_f32 v75, v75, v183
    v_cvt_pk_bf16_f32 v140, v72, v73
    v_cvt_pk_bf16_f32 v141, v74, v75
    v_fma_f32 v88, -v184, v196, v88
    v_mul_f32 v88, v88, v185
    v_fma_f32 v89, -v186, v196, v89
    v_mul_f32 v89, v89, v187
    v_fma_f32 v90, -v188, v196, v90
    v_mul_f32 v90, v90, v189
    v_fma_f32 v91, -v190, v196, v91
    v_mul_f32 v91, v91, v191
    v_cvt_pk_bf16_f32 v142, v88, v89
    v_cvt_pk_bf16_f32 v143, v90, v91
    buffer_store_dwordx4 v[140:143], v22, s[20:23], s42 offen offset:1024 sc0 sc1
    v_fma_f32 v76, -v176, v198, v76
    v_mul_f32 v76, v76, v177
    v_fma_f32 v77, -v178, v198, v77
    v_mul_f32 v77, v77, v179
    v_fma_f32 v78, -v180, v198, v78
    v_mul_f32 v78, v78, v181
    v_fma_f32 v79, -v182, v198, v79
    v_mul_f32 v79, v79, v183
    v_cvt_pk_bf16_f32 v144, v76, v77
    v_cvt_pk_bf16_f32 v145, v78, v79
    v_fma_f32 v92, -v184, v198, v92
    v_mul_f32 v92, v92, v185
    v_fma_f32 v93, -v186, v198, v93
    v_mul_f32 v93, v93, v187
    v_fma_f32 v94, -v188, v198, v94
    v_mul_f32 v94, v94, v189
    v_fma_f32 v95, -v190, v198, v95
    v_mul_f32 v95, v95, v191
    v_cvt_pk_bf16_f32 v146, v92, v93
    v_cvt_pk_bf16_f32 v147, v94, v95
    buffer_store_dwordx4 v[144:147], v22, s[20:23], s43 offen offset:1024 sc0 sc1
    s_bfe_u32 s36, s3, 0x10001
    s_lshl_b32 s35, s29, 1
    s_add_u32 s35, s35, s36
    s_lshl_b32 s35, s35, 2
    s_add_u32 s35, s35, s31
    s_lshl_b32 s35, s35, 3
    s_and_b32 s36, s30, 7
    s_add_u32 s35, s35, s36
    s_lshl_b32 s35, s35, 7
    s_lshl_b32 s36, s32, 2
    s_add_u32 s35, s35, s36
    s_add_u32 s35, s35, 13180928
    s_waitcnt vmcnt(0)
    buffer_store_dword v25, v24, s[20:23], s35 offen sc0 sc1
    s_barrier
    s_branch k1_kernel_fin
k1_kernel_aux:
    s_mov_b32 s50, s28
    s_mov_b32 s51, s29
    s_memrealtime s[66:67]
    v_lshlrev_b32 v6, 7, v2
    v_lshrrev_b32 v3, 4, v2
    v_and_b32 v4, 15, v2
    v_lshlrev_b32 v7, 12, v3
    v_lshl_add_u32 v7, v4, 7, v7
    v_lshlrev_b32 v5, 10, v3
    v_lshl_add_u32 v5, v4, 4, v5
    s_lshl_b32 s35, s50, 3
    s_add_u32 s56, s35, s3
    s_add_u32 s35, s35, s32
    s_lshl_b32 s48, s26, 10
    s_lshl_b32 s49, s35, 3
    s_add_u32 s48, s48, s49
    s_lshl_b32 s48, s48, 12
    s_lshl_b32 s49, s27, 11
    s_add_u32 s48, s48, s49
    s_add_u32 s49, s48, 16384
    s_waitcnt lgkmcnt(0)
    s_mov_b32 s28, s44
    s_and_b32 s29, s45, 0xffff
    s_mov_b32 s30, 256
    s_mov_b32 s31, 0x00020000
    s_mov_b32 s20, s46
    s_and_b32 s21, s47, 0xffff
    s_mov_b32 s22, 14680064
    s_mov_b32 s23, 0x00020000
    s_xor_b32 s62, s2, 8
    s_or_b32 s62, s62, s32
    s_cmp_lg_u32 s62, 0
    s_cbranch_scc1 k1_kernel_nopub
    s_or_b32 s62, s66, 1
    v_mov_b32 v25, s62
    v_mov_b32 v24, 0
    buffer_store_dword v25, v24, s[28:31], 0 offen sc0 sc1
    s_mov_b32 s62, 13631488
    buffer_store_dword v25, v24, s[20:23], s62 offen sc0 sc1
k1_kernel_nopub:
    s_mov_b32 s12, s4
    s_and_b32 s13, s5, 0xffff
    s_mov_b32 s14, 2097152
    s_mov_b32 s15, 0x00020000
    s_cmp_ge_u32 s32, 6
    s_cbranch_scc1 k1_kernel_touch
    s_cmp_ge_u32 s32, 4
    s_cbranch_scc1 k1_kernel_csw
    s_lshl_b32 s33, s56, 4
    s_lshl_b32 s34, s32, 2
    s_add_u32 s33, s33, s34
    s_lshl_b32 s34, s33, 10
    buffer_load_dwordx4 v[16:19], v5, s[12:15], s34 offen offset:0
    buffer_load_dwordx4 v[20:23], v5, s[12:15], s34 offen offset:256
    buffer_load_dwordx4 v[24:27], v5, s[12:15], s34 offen offset:512
    buffer_load_dwordx4 v[28:31], v5, s[12:15], s34 offen offset:768
    v_mov_b32 v9, 0
k1_kernel_nl1:
    buffer_load_dword v15, v9, s[28:31], 0 offen sc1
    s_waitcnt vmcnt(0)
    v_readfirstlane_b32 s57, v15
    s_cmp_lg_u32 s57, 0
    s_cbranch_scc1 k1_kernel_nd1
    s_sleep 1
    s_sub_u32 s69, s69, 1
    s_cbranch_scc0 k1_kernel_nl1
    s_mov_b32 s69, 0
k1_kernel_nd1:
    v_lshlrev_b32 v32, 16, v16
    v_and_b32 v33, s53, v16
    v_lshlrev_b32 v34, 16, v17
    v_and_b32 v35, s53, v17
    v_lshlrev_b32 v36, 16, v18
    v_and_b32 v37, s53, v18
    v_lshlrev_b32 v38, 16, v19
    v_and_b32 v39, s53, v19
    v_lshlrev_b32 v40, 16, v20
    v_and_b32 v41, s53, v20
    v_lshlrev_b32 v42, 16, v21
    v_and_b32 v43, s53, v21
    v_lshlrev_b32 v44, 16, v22
    v_and_b32 v45, s53, v22
    v_lshlrev_b32 v46, 16, v23
    v_and_b32 v47, s53, v23
    v_lshlrev_b32 v48, 16, v24
    v_and_b32 v49, s53, v24
    v_lshlrev_b32 v50, 16, v25
    v_and_b32 v51, s53, v25
    v_lshlrev_b32 v52, 16, v26
    v_and_b32 v53, s53, v26
    v_lshlrev_b32 v54, 16, v27
    v_and_b32 v55, s53, v27
    v_lshlrev_b32 v56, 16, v28
    v_and_b32 v57, s53, v28
    v_lshlrev_b32 v58, 16, v29
    v_and_b32 v59, s53, v29
    v_lshlrev_b32 v60, 16, v30
    v_and_b32 v61, s53, v30
    v_lshlrev_b32 v62, 16, v31
    v_and_b32 v63, s53, v31
    v_add_f32 v8, v32, v33
    v_add_f32 v9, v34, v35
    v_add_f32 v8, v8, v36
    v_add_f32 v9, v9, v37
    v_add_f32 v8, v8, v38
    v_add_f32 v9, v9, v39
    v_add_f32 v8, v8, v40
    v_add_f32 v9, v9, v41
    v_add_f32 v8, v8, v42
    v_add_f32 v9, v9, v43
    v_add_f32 v8, v8, v44
    v_add_f32 v9, v9, v45
    v_add_f32 v8, v8, v46
    v_add_f32 v9, v9, v47
    v_add_f32 v8, v8, v48
    v_add_f32 v9, v9, v49
    v_add_f32 v8, v8, v50
    v_add_f32 v9, v9, v51
    v_add_f32 v8, v8, v52
    v_add_f32 v9, v9, v53
    v_add_f32 v8, v8, v54
    v_add_f32 v9, v9, v55
    v_add_f32 v8, v8, v56
    v_add_f32 v9, v9, v57
    v_add_f32 v8, v8, v58
    v_add_f32 v9, v9, v59
    v_add_f32 v8, v8, v60
    v_add_f32 v9, v9, v61
    v_add_f32 v8, v8, v62
    v_add_f32 v9, v9, v63
    v_add_f32 v8, v8, v9
    s_nop 1
    v_add_f32_dpp v8, v8, v8 quad_perm:[1,0,3,2] row_mask:0xf bank_mask:0xf
    s_nop 1
    v_add_f32_dpp v8, v8, v8 quad_perm:[2,3,0,1] row_mask:0xf bank_mask:0xf
    s_nop 1
    v_add_f32_dpp v8, v8, v8 row_half_mirror row_mask:0xf bank_mask:0xf
    s_nop 1
    v_add_f32_dpp v8, v8, v8 row_mirror row_mask:0xf bank_mask:0xf
    v_mul_f32 v8, 0x3b000000, v8
    v_mov_b32 v10, 0
    v_mov_b32 v11, 0
    v_sub_f32 v32, v32, v8
    v_sub_f32 v33, v33, v8
    v_fmac_f32 v10, v32, v32
    v_fmac_f32 v11, v33, v33
    v_sub_f32 v34, v34, v8
    v_sub_f32 v35, v35, v8
    v_fmac_f32 v10, v34, v34
    v_fmac_f32 v11, v35, v35
    v_sub_f32 v36, v36, v8
    v_sub_f32 v37, v37, v8
    v_fmac_f32 v10, v36, v36
    v_fmac_f32 v11, v37, v37
    v_sub_f32 v38, v38, v8
    v_sub_f32 v39, v39, v8
    v_fmac_f32 v10, v38, v38
    v_fmac_f32 v11, v39, v39
    v_sub_f32 v40, v40, v8
    v_sub_f32 v41, v41, v8
    v_fmac_f32 v10, v40, v40
    v_fmac_f32 v11, v41, v41
    v_sub_f32 v42, v42, v8
    v_sub_f32 v43, v43, v8
    v_fmac_f32 v10, v42, v42
    v_fmac_f32 v11, v43, v43
    v_sub_f32 v44, v44, v8
    v_sub_f32 v45, v45, v8
    v_fmac_f32 v10, v44, v44
    v_fmac_f32 v11, v45, v45
    v_sub_f32 v46, v46, v8
    v_sub_f32 v47, v47, v8
    v_fmac_f32 v10, v46, v46
    v_fmac_f32 v11, v47, v47
    v_sub_f32 v48, v48, v8
    v_sub_f32 v49, v49, v8
    v_fmac_f32 v10, v48, v48
    v_fmac_f32 v11, v49, v49
    v_sub_f32 v50, v50, v8
    v_sub_f32 v51, v51, v8
    v_fmac_f32 v10, v50, v50
    v_fmac_f32 v11, v51, v51
    v_sub_f32 v52, v52, v8
    v_sub_f32 v53, v53, v8
    v_fmac_f32 v10, v52, v52
    v_fmac_f32 v11, v53, v53
    v_sub_f32 v54, v54, v8
    v_sub_f32 v55, v55, v8
    v_fmac_f32 v10, v54, v54
    v_fmac_f32 v11, v55, v55
    v_sub_f32 v56, v56, v8
    v_sub_f32 v57, v57, v8
    v_fmac_f32 v10, v56, v56
    v_fmac_f32 v11, v57, v57
    v_sub_f32 v58, v58, v8
    v_sub_f32 v59, v59, v8
    v_fmac_f32 v10, v58, v58
    v_fmac_f32 v11, v59, v59
    v_sub_f32 v60, v60, v8
    v_sub_f32 v61, v61, v8
    v_fmac_f32 v10, v60, v60
    v_fmac_f32 v11, v61, v61
    v_sub_f32 v62, v62, v8
    v_sub_f32 v63, v63, v8
    v_fmac_f32 v10, v62, v62
    v_fmac_f32 v11, v63, v63
    v_add_f32 v10, v10, v11
    s_nop 1
    v_add_f32_dpp v10, v10, v10 quad_perm:[1,0,3,2] row_mask:0xf bank_mask:0xf
    s_nop 1
    v_add_f32_dpp v10, v10, v10 quad_perm:[2,3,0,1] row_mask:0xf bank_mask:0xf
    s_nop 1
    v_add_f32_dpp v10, v10, v10 row_half_mirror row_mask:0xf bank_mask:0xf
    s_nop 1
    v_add_f32_dpp v10, v10, v10 row_mirror row_mask:0xf bank_mask:0xf
    v_mul_f32 v10, 0x3b000000, v10
    v_cvt_pk_bf16_f32 v12, v8, v8
    v_lshlrev_b32 v12, 16, v12
    v_cvt_pk_bf16_f32 v10, v10, v10
    v_lshlrev_b32 v10, 16, v10
    v_add_f32 v10, 0x3727c5ac, v10
    v_cvt_pk_bf16_f32 v10, v10, v10
    v_lshlrev_b32 v10, 16, v10
    v_sqrt_f32 v10, v10
    s_nop 0
    v_cvt_pk_bf16_f32 v10, v10, v10
    v_and_b32 v10, 0xffff, v10
    v_or_b32 v12, v12, v10
    v_mov_b32 v13, v15
    v_lshlrev_b32 v14, 3, v3
    s_lshl_b32 s36, s33, 3
    s_add_u32 s36, s36, 13115392
    v_cmp_eq_u32 vcc, 0, v4
    s_and_saveexec_b64 s[54:55], vcc
    buffer_store_dwordx2 v[12:13], v14, s[20:23], s36 offen sc0 sc1
    s_mov_b64 exec, s[54:55]
    s_branch k1_kernel_auxj
k1_kernel_csw:
    s_lshl_b32 s33, s56, 3
    s_sub_u32 s34, s32, 4
    s_lshl_b32 s34, s34, 2
    s_add_u32 s33, s33, s34
    s_cmp_ge_u32 s33, 512
    s_cselect_b32 s58, s10, s8
    s_cselect_b32 s59, s11, s9
    s_mov_b32 s16, s58
    s_and_b32 s17, s59, 0xffff
    s_mov_b32 s18, 524288
    s_mov_b32 s19, 0x00020000
    s_and_b32 s34, s33, 511
    s_lshl_b32 s34, s34, 10
    buffer_load_dwordx4 v[16:19], v5, s[16:19], s34 offen offset:0
    buffer_load_dwordx4 v[20:23], v5, s[16:19], s34 offen offset:256
    buffer_load_dwordx4 v[24:27], v5, s[16:19], s34 offen offset:512
    buffer_load_dwordx4 v[28:31], v5, s[16:19], s34 offen offset:768
    v_mov_b32 v8, 0
    v_mov_b32 v9, 0
k1_kernel_nl2:
    buffer_load_dword v15, v9, s[28:31], 0 offen sc1
    s_waitcnt vmcnt(0)
    v_readfirstlane_b32 s57, v15
    s_cmp_lg_u32 s57, 0
    s_cbranch_scc1 k1_kernel_nd2
    s_sleep 1
    s_sub_u32 s69, s69, 1
    s_cbranch_scc0 k1_kernel_nl2
    s_mov_b32 s69, 0
k1_kernel_nd2:
    v_lshlrev_b32 v32, 16, v16
    v_and_b32 v33, s53, v16
    v_add_f32 v8, v8, v32
    v_add_f32 v9, v9, v33
    v_lshlrev_b32 v34, 16, v17
    v_and_b32 v35, s53, v17
    v_add_f32 v8, v8, v34
    v_add_f32 v9, v9, v35
    v_lshlrev_b32 v36, 16, v18
    v_and_b32 v37, s53, v18
    v_add_f32 v8, v8, v36
    v_add_f32 v9, v9, v37
    v_lshlrev_b32 v38, 16, v19
    v_and_b32 v39, s53, v19
    v_add_f32 v8, v8, v38
    v_add_f32 v9, v9, v39
    v_lshlrev_b32 v32, 16, v20
    v_and_b32 v33, s53, v20
    v_add_f32 v8, v8, v32
    v_add_f32 v9, v9, v33
    v_lshlrev_b32 v34, 16, v21
    v_and_b32 v35, s53, v21
    v_add_f32 v8, v8, v34
    v_add_f32 v9, v9, v35
    v_lshlrev_b32 v36, 16, v22
    v_and_b32 v37, s53, v22
    v_add_f32 v8, v8, v36
    v_add_f32 v9, v9, v37
    v_lshlrev_b32 v38, 16, v23
    v_and_b32 v39, s53, v23
    v_add_f32 v8, v8, v38
    v_add_f32 v9, v9, v39
    v_lshlrev_b32 v32, 16, v24
    v_and_b32 v33, s53, v24
    v_add_f32 v8, v8, v32
    v_add_f32 v9, v9, v33
    v_lshlrev_b32 v34, 16, v25
    v_and_b32 v35, s53, v25
    v_add_f32 v8, v8, v34
    v_add_f32 v9, v9, v35
    v_lshlrev_b32 v36, 16, v26
    v_and_b32 v37, s53, v26
    v_add_f32 v8, v8, v36
    v_add_f32 v9, v9, v37
    v_lshlrev_b32 v38, 16, v27
    v_and_b32 v39, s53, v27
    v_add_f32 v8, v8, v38
    v_add_f32 v9, v9, v39
    v_lshlrev_b32 v32, 16, v28
    v_and_b32 v33, s53, v28
    v_add_f32 v8, v8, v32
    v_add_f32 v9, v9, v33
    v_lshlrev_b32 v34, 16, v29
    v_and_b32 v35, s53, v29
    v_add_f32 v8, v8, v34
    v_add_f32 v9, v9, v35
    v_lshlrev_b32 v36, 16, v30
    v_and_b32 v37, s53, v30
    v_add_f32 v8, v8, v36
    v_add_f32 v9, v9, v37
    v_lshlrev_b32 v38, 16, v31
    v_and_b32 v39, s53, v31
    v_add_f32 v8, v8, v38
    v_add_f32 v9, v9, v39
    v_add_f32 v8, v8, v9
    s_nop 1
    v_add_f32_dpp v8, v8, v8 quad_perm:[1,0,3,2] row_mask:0xf bank_mask:0xf
    s_nop 1
    v_add_f32_dpp v8, v8, v8 quad_perm:[2,3,0,1] row_mask:0xf bank_mask:0xf
    s_nop 1
    v_add_f32_dpp v8, v8, v8 row_half_mirror row_mask:0xf bank_mask:0xf
    s_nop 1
    v_add_f32_dpp v8, v8, v8 row_mirror row_mask:0xf bank_mask:0xf
    v_lshlrev_b32 v14, 3, v3
    v_mov_b32 v9, v15
    s_lshl_b32 s36, s33, 3
    s_add_u32 s36, s36, 13131776
    v_cmp_eq_u32 vcc, 0, v4
    s_and_saveexec_b64 s[54:55], vcc
    buffer_store_dwordx2 v[8:9], v14, s[20:23], s36 offen sc0 sc1
    s_mov_b64 exec, s[54:55]
    s_branch k1_kernel_auxj
k1_kernel_touch:
    s_cmp_eq_u32 s51, 1
    s_cselect_b32 s58, s10, s8
    s_cselect_b32 s59, s11, s9
    s_mov_b32 s16, s58
    s_and_b32 s17, s59, 0xffff
    s_mov_b32 s18, 524288
    s_mov_b32 s19, 0x00020000
    s_lshl_b32 s36, s27, 20
    s_lshl_b32 s37, s26, 19
    s_add_u32 s36, s36, s37
    s_lshl_b32 s37, s50, 1
    s_add_u32 s37, s37, s32
    s_sub_u32 s37, s37, 6
    s_lshl_b32 s37, s37, 14
    s_add_u32 s36, s36, s37
    buffer_load_dword v202, v6, s[12:15], s36 offen
    buffer_load_dword v203, v6, s[16:19], s37 offen
    s_add_u32 s36, s36, 8192
    s_add_u32 s37, s37, 8192
    buffer_load_dword v204, v6, s[12:15], s36 offen
    buffer_load_dword v205, v6, s[16:19], s37 offen
k1_kernel_auxj:
    s_cmp_eq_u32 s51, 1
    s_cselect_b32 s40, s42, s40
    s_cselect_b32 s41, s43, s41
    s_mov_b32 s24, s40
    s_and_b32 s25, s41, 0xffff
    s_mov_b32 s26, 8388608
    s_mov_b32 s27, 0x00020000
    s_barrier
    v_cmp_gt_u32 vcc, 8, v4
    s_and_saveexec_b64 s[54:55], vcc
    buffer_load_dword v204, v7, s[24:27], s48 offen
    buffer_load_dword v205, v7, s[24:27], s49 offen
    s_mov_b64 exec, s[54:55]
k1_kernel_pfskip:
    s_cmp_ge_u32 s32, 6
    s_cbranch_scc1 k1_kernel_fina
    s_lshr_b32 s58, s32, 1
    s_lshl_b32 s58, s58, 3
    s_add_u32 s58, s58, 56
    s_load_dwordx2 s[60:61], s[0:1], s58
    s_mul_i32 s62, s56, 14336
    s_and_b32 s63, s32, 1
    s_mul_i32 s63, s63, 7168
    s_add_u32 s62, s62, s63
    s_add_u32 s63, s62, 7168
    s_waitcnt lgkmcnt(0)
    s_mov_b32 s16, s60
    s_and_b32 s17, s61, 0xffff
    s_mov_b32 s18, s63
    s_mov_b32 s19, 0x00020000
    buffer_load_dword v206, v6, s[16:19], s62 offen
k1_kernel_fina:
    s_xor_b32 s32, s32, 4
k1_kernel_fin:
    s_load_dwordx2 s[10:11], s[0:1], 88
    s_load_dwordx4 s[4:7], s[0:1], 8
    s_load_dwordx2 s[8:9], s[0:1], 96
    s_load_dwordx4 s[56:59], s[0:1], 56
    s_load_dwordx2 s[60:61], s[0:1], 72
    s_load_dwordx4 s[64:67], s[0:1], 56
    s_load_dwordx2 s[68:69], s[0:1], 72
    s_and_b32 s3, s2, 7
    s_lshr_b32 s28, s2, 3
    s_and_b32 s29, s3, 1
    s_bfe_u32 s27, s3, 0x10001
    s_lshr_b32 s30, s3, 2
    s_lshl_b32 s30, s30, 3
    s_and_b32 s31, s28, 7
    s_add_u32 s30, s30, s31
    s_lshr_b32 s31, s28, 3
    v_mbcnt_lo_u32_b32 v2, -1, 0
    v_mbcnt_hi_u32_b32 v2, -1, v2
    v_lshlrev_b32 v3, 4, v2
    s_cmp_lt_u32 s32, 4
    s_cbranch_scc1 k1_kernelg_cons
    s_sub_u32 s33, s32, 4
    v_lshrrev_b32 v4, 3, v2
    v_and_b32 v5, 7, v2
    v_lshrrev_b32 v6, 4, v2
    v_xor_b32 v6, v6, v5
    v_xor_b32 v7, 4, v6
    v_lshlrev_b32 v4, 12, v4
    v_lshl_add_u32 v6, v6, 4, v4
    v_lshl_add_u32 v7, v7, 4, v4
    v_mov_b32 v8, v6
    v_add_u32 v9, 31744, v7
    v_add_u32 v10, 63488, v6
    v_add_u32 v11, 95232, v7
    v_add_u32 v12, 63488, v3
    s_lshl_b32 s35, s30, 19
    s_lshl_b32 s34, s33, 17
    s_add_u32 s35, s35, s34
    s_lshl_b32 s34, s27, 11
    s_add_u32 s35, s35, s34
    s_lshl_b32 s36, s29, 5
    s_lshl_b32 s34, s31, 3
    s_add_u32 s36, s36, s34
    s_lshl_b32 s34, s33, 1
    s_add_u32 s36, s36, s34
    s_lshl_b32 s36, s36, 6
    s_lshl_b32 s34, s27, 5
    s_add_u32 s36, s36, s34
    s_lshl_b32 s36, s36, 10
    s_lshl_b32 s37, s33, 12
    s_add_u32 s34, s31, 0
    s_and_b32 s34, s34, 3
    s_lshl_b32 s38, s34, 7
    s_add_u32 s44, s35, s38
    s_lshl_b32 s38, s34, 11
    s_add_u32 s48, s36, s38
    s_add_u32 s34, s31, 1
    s_and_b32 s34, s34, 3
    s_lshl_b32 s38, s34, 7
    s_add_u32 s45, s35, s38
    s_lshl_b32 s38, s34, 11
    s_add_u32 s49, s36, s38
    s_add_u32 s34, s31, 2
    s_and_b32 s34, s34, 3
    s_lshl_b32 s38, s34, 7
    s_add_u32 s46, s35, s38
    s_lshl_b32 s38, s34, 11
    s_add_u32 s50, s36, s38
    s_add_u32 s34, s31, 3
    s_and_b32 s34, s34, 3
    s_lshl_b32 s38, s34, 7
    s_add_u32 s47, s35, s38
    s_lshl_b32 s38, s34, 11
    s_add_u32 s51, s36, s38
    s_waitcnt lgkmcnt(0)
    s_cmp_eq_u32 s29, 1
    s_cselect_b32 s4, s6, s4
    s_cselect_b32 s5, s7, s5
    s_mov_b32 s12, s4
    s_and_b32 s13, s5, 0xffff
    s_mov_b32 s14, 8388608
    s_mov_b32 s15, 0x00020000
    s_mov_b32 s16, s8
    s_and_b32 s17, s9, 0xffff
    s_mov_b32 s18, 14680064
    s_mov_b32 s19, 0x00020000
    s_add_u32 m0, s37, 98304
    s_add_u32 s38, s44, 0
    buffer_load_dwordx4 v8, s[12:15], s38 offen offset:0 lds
    buffer_load_dwordx4 v9, s[12:15], s38 offen offset:1024 lds
    buffer_load_dwordx4 v10, s[12:15], s38 offen offset:2048 lds
    buffer_load_dwordx4 v11, s[12:15], s38 offen offset:3072 lds
    s_add_u32 m0, s37, 131072
    s_add_u32 s38, s45, 0
    buffer_load_dwordx4 v8, s[12:15], s38 offen offset:0 lds
    buffer_load_dwordx4 v9, s[12:15], s38 offen offset:1024 lds
    buffer_load_dwordx4 v10, s[12:15], s38 offen offset:2048 lds
    buffer_load_dwordx4 v11, s[12:15], s38 offen offset:3072 lds
    s_add_u32 m0, s37, 0
    s_add_u32 s38, s46, 0
    buffer_load_dwordx4 v8, s[12:15], s38 offen offset:0 lds
    buffer_load_dwordx4 v9, s[12:15], s38 offen offset:1024 lds
    buffer_load_dwordx4 v10, s[12:15], s38 offen offset:2048 lds
    buffer_load_dwordx4 v11, s[12:15], s38 offen offset:3072 lds
    s_add_u32 m0, s37, 32768
    s_add_u32 s38, s47, 0
    buffer_load_dwordx4 v8, s[12:15], s38 offen offset:0 lds
    buffer_load_dwordx4 v9, s[12:15], s38 offen offset:1024 lds
    buffer_load_dwordx4 v10, s[12:15], s38 offen offset:2048 lds
    buffer_load_dwordx4 v11, s[12:15], s38 offen offset:3072 lds
    s_mov_b32 s20, s10
    s_and_b32 s21, s11, 0xffff
    s_mov_b32 s22, 256
    s_mov_b32 s23, 0x00020000
    s_lshl_b32 s52, s29, 1
    s_add_u32 s52, s52, s27
    s_lshl_b32 s52, s52, 2
    s_add_u32 s52, s52, s31
    s_lshl_b32 s52, s52, 10
    s_add_u32 s52, s52, 13180928
    v_bfe_u32 v13, v2, 2, 3
    v_lshlrev_b32 v13, 7, v13
    v_and_b32 v14, 3, v2
    v_lshl_add_u32 v13, v14, 2, v13
    v_mov_b32 v14, 0
    s_mov_b32 s55, 0x40000
k1_kernelg_np:
    buffer_load_dword v15, v14, s[20:23], 0 offen sc1
    v_and_b32 v17, 3, v2
    v_lshlrev_b32 v17, 12, v17
    v_add_u32 v17, 114688, v17
    s_add_u32 s54, s37, 114688
    v_mov_b32 v18, s54
    s_waitcnt vmcnt(0)
    v_readfirstlane_b32 s53, v15
    s_cmp_lg_u32 s53, 0
    s_cbranch_scc1 k1_kernelg_nd
    s_sub_u32 s55, s55, 1
    s_cbranch_scc0 k1_kernelg_np
    s_mov_b32 s55, 0
k1_kernelg_nd:
    s_cmp_lg_u32 s33, 0
    s_cbranch_scc1 k1_kernelg_lp
k1_kernelg_ep:
    buffer_load_dword v16, v13, s[16:19], s52 offen sc1
    s_waitcnt vmcnt(0)
    v_cmp_ne_u32 vcc, v15, v16
    s_or_b32 s62, vcc_lo, vcc_hi
    s_cbranch_scc0 k1_kernelg_eo
    s_sleep 4
    s_sub_u32 s55, s55, 1
    s_cbranch_scc0 k1_kernelg_ep
k1_kernelg_eo:
    ds_write_b32 v17, v15
    s_waitcnt lgkmcnt(0)
    s_branch k1_kernelg_ed
k1_kernelg_lp:
    ds_read_b32 v16, v18
    s_waitcnt lgkmcnt(0)
    v_readfirstlane_b32 s62, v16
    s_cmp_eq_u32 s62, s53
    s_cbranch_scc1 k1_kernelg_ed
    s_sleep 1
    s_sub_u32 s55, s55, 1
    s_cbranch_scc0 k1_kernelg_lp
k1_kernelg_ed:
    s_add_u32 m0, s37, 114688
    s_add_u32 s39, s48, 0
    buffer_load_dwordx4 v3, s[16:19], s39 offen offset:0 sc1 lds
    buffer_load_dwordx4 v3, s[16:19], s39 offen offset:1024 sc1 lds
    buffer_load_dwordx4 v12, s[16:19], s39 offen offset:2048 sc1 lds
    buffer_load_dwordx4 v12, s[16:19], s39 offen offset:3072 sc1 lds
    s_add_u32 m0, s37, 147456
    s_add_u32 s39, s49, 0
    buffer_load_dwordx4 v3, s[16:19], s39 offen offset:0 sc1 lds
    buffer_load_dwordx4 v3, s[16:19], s39 offen offset:1024 sc1 lds
    buffer_load_dwordx4 v12, s[16:19], s39 offen offset:2048 sc1 lds
    buffer_load_dwordx4 v12, s[16:19], s39 offen offset:3072 sc1 lds
    s_add_u32 m0, s37, 16384
    s_add_u32 s39, s50, 0
    buffer_load_dwordx4 v3, s[16:19], s39 offen offset:0 sc1 lds
    buffer_load_dwordx4 v3, s[16:19], s39 offen offset:1024 sc1 lds
    buffer_load_dwordx4 v12, s[16:19], s39 offen offset:2048 sc1 lds
    buffer_load_dwordx4 v12, s[16:19], s39 offen offset:3072 sc1 lds
    s_add_u32 m0, s37, 49152
    s_add_u32 s39, s51, 0
    buffer_load_dwordx4 v3, s[16:19], s39 offen offset:0 sc1 lds
    buffer_load_dwordx4 v3, s[16:19], s39 offen offset:1024 sc1 lds
    buffer_load_dwordx4 v12, s[16:19], s39 offen offset:2048 sc1 lds
    buffer_load_dwordx4 v12, s[16:19], s39 offen offset:3072 sc1 lds
    s_waitcnt vmcnt(12)
    s_barrier
    s_add_u32 m0, s37, 65536
    s_add_u32 s38, s44, 512
    buffer_load_dwordx4 v8, s[12:15], s38 offen offset:0 lds
    buffer_load_dwordx4 v9, s[12:15], s38 offen offset:1024 lds
    buffer_load_dwordx4 v10, s[12:15], s38 offen offset:2048 lds
    buffer_load_dwordx4 v11, s[12:15], s38 offen offset:3072 lds
    s_add_u32 m0, s37, 81920
    s_add_u32 s39, s48, 8192
    buffer_load_dwordx4 v3, s[16:19], s39 offen offset:0 sc1 lds
    buffer_load_dwordx4 v3, s[16:19], s39 offen offset:1024 sc1 lds
    buffer_load_dwordx4 v12, s[16:19], s39 offen offset:2048 sc1 lds
    buffer_load_dwordx4 v12, s[16:19], s39 offen offset:3072 sc1 lds
    s_waitcnt vmcnt(16)
    s_barrier
    s_add_u32 m0, s37, 98304
    s_add_u32 s38, s45, 512
    buffer_load_dwordx4 v8, s[12:15], s38 offen offset:0 lds
    buffer_load_dwordx4 v9, s[12:15], s38 offen offset:1024 lds
    buffer_load_dwordx4 v10, s[12:15], s38 offen offset:2048 lds
    buffer_load_dwordx4 v11, s[12:15], s38 offen offset:3072 lds
    s_add_u32 m0, s37, 114688
    s_add_u32 s39, s49, 8192
    buffer_load_dwordx4 v3, s[16:19], s39 offen offset:0 sc1 lds
    buffer_load_dwordx4 v3, s[16:19], s39 offen offset:1024 sc1 lds
    buffer_load_dwordx4 v12, s[16:19], s39 offen offset:2048 sc1 lds
    buffer_load_dwordx4 v12, s[16:19], s39 offen offset:3072 sc1 lds
    s_waitcnt vmcnt(20)
    s_barrier
    s_add_u32 m0, s37, 131072
    s_add_u32 s38, s46, 512
    buffer_load_dwordx4 v8, s[12:15], s38 offen offset:0 lds
    buffer_load_dwordx4 v9, s[12:15], s38 offen offset:1024 lds
    buffer_load_dwordx4 v10, s[12:15], s38 offen offset:2048 lds
    buffer_load_dwordx4 v11, s[12:15], s38 offen offset:3072 lds
    s_add_u32 m0, s37, 147456
    s_add_u32 s39, s50, 8192
    buffer_load_dwordx4 v3, s[16:19], s39 offen offset:0 sc1 lds
    buffer_load_dwordx4 v3, s[16:19], s39 offen offset:1024 sc1 lds
    buffer_load_dwordx4 v12, s[16:19], s39 offen offset:2048 sc1 lds
    buffer_load_dwordx4 v12, s[16:19], s39 offen offset:3072 sc1 lds
    s_waitcnt vmcnt(24)
    s_barrier
    s_add_u32 m0, s37, 0
    s_add_u32 s38, s47, 512
    buffer_load_dwordx4 v8, s[12:15], s38 offen offset:0 lds
    buffer_load_dwordx4 v9, s[12:15], s38 offen offset:1024 lds
    buffer_load_dwordx4 v10, s[12:15], s38 offen offset:2048 lds
    buffer_load_dwordx4 v11, s[12:15], s38 offen offset:3072 lds
    s_add_u32 m0, s37, 16384
    s_add_u32 s39, s51, 8192
    buffer_load_dwordx4 v3, s[16:19], s39 offen offset:0 sc1 lds
    buffer_load_dwordx4 v3, s[16:19], s39 offen offset:1024 sc1 lds
    buffer_load_dwordx4 v12, s[16:19], s39 offen offset:2048 sc1 lds
    buffer_load_dwordx4 v12, s[16:19], s39 offen offset:3072 sc1 lds
    s_waitcnt vmcnt(24)
    s_barrier
    s_add_u32 m0, s37, 32768
    s_add_u32 s38, s44, 1024
    buffer_load_dwordx4 v8, s[12:15], s38 offen offset:0 lds
    buffer_load_dwordx4 v9, s[12:15], s38 offen offset:1024 lds
    buffer_load_dwordx4 v10, s[12:15], s38 offen offset:2048 lds
    buffer_load_dwordx4 v11, s[12:15], s38 offen offset:3072 lds
    s_add_u32 m0, s37, 49152
    s_add_u32 s39, s48, 16384
    buffer_load_dwordx4 v3, s[16:19], s39 offen offset:0 sc1 lds
    buffer_load_dwordx4 v3, s[16:19], s39 offen offset:1024 sc1 lds
    buffer_load_dwordx4 v12, s[16:19], s39 offen offset:2048 sc1 lds
    buffer_load_dwordx4 v12, s[16:19], s39 offen offset:3072 sc1 lds
    s_waitcnt vmcnt(24)
    s_barrier
    s_add_u32 m0, s37, 65536
    s_add_u32 s38, s45, 1024
    buffer_load_dwordx4 v8, s[12:15], s38 offen offset:0 lds
    buffer_load_dwordx4 v9, s[12:15], s38 offen offset:1024 lds
    buffer_load_dwordx4 v10, s[12:15], s38 offen offset:2048 lds
    buffer_load_dwordx4 v11, s[12:15], s38 offen offset:3072 lds
    s_add_u32 m0, s37, 81920
    s_add_u32 s39, s49, 16384
    buffer_load_dwordx4 v3, s[16:19], s39 offen offset:0 sc1 lds
    buffer_load_dwordx4 v3, s[16:19], s39 offen offset:1024 sc1 lds
    buffer_load_dwordx4 v12, s[16:19], s39 offen offset:2048 sc1 lds
    buffer_load_dwordx4 v12, s[16:19], s39 offen offset:3072 sc1 lds
    s_waitcnt vmcnt(24)
    s_barrier
    s_add_u32 m0, s37, 98304
    s_add_u32 s38, s46, 1024
    buffer_load_dwordx4 v8, s[12:15], s38 offen offset:0 lds
    buffer_load_dwordx4 v9, s[12:15], s38 offen offset:1024 lds
    buffer_load_dwordx4 v10, s[12:15], s38 offen offset:2048 lds
    buffer_load_dwordx4 v11, s[12:15], s38 offen offset:3072 lds
    s_add_u32 m0, s37, 114688
    s_add_u32 s39, s50, 16384
    buffer_load_dwordx4 v3, s[16:19], s39 offen offset:0 sc1 lds
    buffer_load_dwordx4 v3, s[16:19], s39 offen offset:1024 sc1 lds
    buffer_load_dwordx4 v12, s[16:19], s39 offen offset:2048 sc1 lds
    buffer_load_dwordx4 v12, s[16:19], s39 offen offset:3072 sc1 lds
    s_waitcnt vmcnt(24)
    s_barrier
    s_add_u32 m0, s37, 131072
    s_add_u32 s38, s47, 1024
    buffer_load_dwordx4 v8, s[12:15], s38 offen offset:0 lds
    buffer_load_dwordx4 v9, s[12:15], s38 offen offset:1024 lds
    buffer_load_dwordx4 v10, s[12:15], s38 offen offset:2048 lds
    buffer_load_dwordx4 v11, s[12:15], s38 offen offset:3072 lds
    s_add_u32 m0, s37, 147456
    s_add_u32 s39, s51, 16384
    buffer_load_dwordx4 v3, s[16:19], s39 offen offset:0 sc1 lds
    buffer_load_dwordx4 v3, s[16:19], s39 offen offset:1024 sc1 lds
    buffer_load_dwordx4 v12, s[16:19], s39 offen offset:2048 sc1 lds
    buffer_load_dwordx4 v12, s[16:19], s39 offen offset:3072 sc1 lds
    s_waitcnt vmcnt(24)
    s_barrier
    s_add_u32 m0, s37, 0
    s_add_u32 s38, s44, 1536
    buffer_load_dwordx4 v8, s[12:15], s38 offen offset:0 lds
    buffer_load_dwordx4 v9, s[12:15], s38 offen offset:1024 lds
    buffer_load_dwordx4 v10, s[12:15], s38 offen offset:2048 lds
    buffer_load_dwordx4 v11, s[12:15], s38 offen offset:3072 lds
    s_add_u32 m0, s37, 16384
    s_add_u32 s39, s48, 24576
    buffer_load_dwordx4 v3, s[16:19], s39 offen offset:0 sc1 lds
    buffer_load_dwordx4 v3, s[16:19], s39 offen offset:1024 sc1 lds
    buffer_load_dwordx4 v12, s[16:19], s39 offen offset:2048 sc1 lds
    buffer_load_dwordx4 v12, s[16:19], s39 offen offset:3072 sc1 lds
    s_waitcnt vmcnt(24)
    s_barrier
    s_add_u32 m0, s37, 32768
    s_add_u32 s38, s45, 1536
    buffer_load_dwordx4 v8, s[12:15], s38 offen offset:0 lds
    buffer_load_dwordx4 v9, s[12:15], s38 offen offset:1024 lds
    buffer_load_dwordx4 v10, s[12:15], s38 offen offset:2048 lds
    buffer_load_dwordx4 v11, s[12:15], s38 offen offset:3072 lds
    s_add_u32 m0, s37, 49152
    s_add_u32 s39, s49, 24576
    buffer_load_dwordx4 v3, s[16:19], s39 offen offset:0 sc1 lds
    buffer_load_dwordx4 v3, s[16:19], s39 offen offset:1024 sc1 lds
    buffer_load_dwordx4 v12, s[16:19], s39 offen offset:2048 sc1 lds
    buffer_load_dwordx4 v12, s[16:19], s39 offen offset:3072 sc1 lds
    s_waitcnt vmcnt(24)
    s_barrier
    s_add_u32 m0, s37, 65536
    s_add_u32 s38, s46, 1536
    buffer_load_dwordx4 v8, s[12:15], s38 offen offset:0 lds
    buffer_load_dwordx4 v9, s[12:15], s38 offen offset:1024 lds
    buffer_load_dwordx4 v10, s[12:15], s38 offen offset:2048 lds
    buffer_load_dwordx4 v11, s[12:15], s38 offen offset:3072 lds
    s_add_u32 m0, s37, 81920
    s_add_u32 s39, s50, 24576
    buffer_load_dwordx4 v3, s[16:19], s39 offen offset:0 sc1 lds
    buffer_load_dwordx4 v3, s[16:19], s39 offen offset:1024 sc1 lds
    buffer_load_dwordx4 v12, s[16:19], s39 offen offset:2048 sc1 lds
    buffer_load_dwordx4 v12, s[16:19], s39 offen offset:3072 sc1 lds
    s_waitcnt vmcnt(24)
    s_barrier
    s_add_u32 m0, s37, 98304
    s_add_u32 s38, s47, 1536
    buffer_load_dwordx4 v8, s[12:15], s38 offen offset:0 lds
    buffer_load_dwordx4 v9, s[12:15], s38 offen offset:1024 lds
    buffer_load_dwordx4 v10, s[12:15], s38 offen offset:2048 lds
    buffer_load_dwordx4 v11, s[12:15], s38 offen offset:3072 lds
    s_add_u32 m0, s37, 114688
    s_add_u32 s39, s51, 24576
    buffer_load_dwordx4 v3, s[16:19], s39 offen offset:0 sc1 lds
    buffer_load_dwordx4 v3, s[16:19], s39 offen offset:1024 sc1 lds
    buffer_load_dwordx4 v12, s[16:19], s39 offen offset:2048 sc1 lds
    buffer_load_dwordx4 v12, s[16:19], s39 offen offset:3072 sc1 lds
    s_cmp_ge_u32 s33, 2
    s_cselect_b32 s56, s66, s64
    s_cselect_b32 s57, s67, s65
    s_cmp_lt_u32 s28, 28
    s_cselect_b32 s62, 1835008, 0
    s_mov_b32 s20, s56
    s_and_b32 s21, s57, 0xffff
    s_mov_b32 s22, s62
    s_mov_b32 s23, 0x00020000
    s_mov_b32 s24, s68
    s_and_b32 s25, s69, 0xffff
    s_mov_b32 s26, s62
    s_mov_b32 s27, 0x00020000
    s_lshr_b32 s58, s28, 2
    s_lshl_b32 s58, s58, 3
    s_add_u32 s58, s58, s3
    s_and_b32 s59, s28, 3
    s_lshl_b32 s62, s59, 1
    s_and_b32 s63, s33, 1
    s_add_u32 s62, s62, s63
    s_mul_i32 s62, s62, 229376
    s_lshr_b32 s63, s58, 1
    s_lshl_b32 s63, s63, 7
    s_add_u32 s62, s62, s63
    s_mov_b32 s63, 3584
    v_mul_lo_u32 v13, v2, s63
    buffer_load_dword v15, v13, s[20:23], s62 offen
    s_lshl_b32 s62, s58, 15
    s_lshl_b32 s63, s59, 13
    s_add_u32 s62, s62, s63
    s_lshl_b32 s63, s33, 11
    s_add_u32 s62, s62, s63
    v_and_b32 v13, 15, v2
    v_lshlrev_b32 v13, 7, v13
    buffer_load_dword v16, v13, s[24:27], s62 offen
    s_waitcnt vmcnt(26)
    s_barrier
    s_waitcnt vmcnt(18)
    s_barrier
    s_waitcnt vmcnt(10)
    s_barrier
    s_waitcnt vmcnt(2)
    s_barrier
    s_branch k1_kernelg_fin
k1_kernelg_cons:
    s_and_b32 s33, s32, 1
    s_lshr_b32 s34, s32, 1
    v_and_b32 v4, 15, v2
    v_lshrrev_b32 v5, 1, v4
    v_lshrrev_b32 v6, 4, v2
    v_xor_b32 v5, v5, v6
    v_lshlrev_b32 v5, 4, v5
    v_lshl_add_u32 v5, v4, 7, v5
    s_lshl_b32 s35, s33, 13
    s_lshl_b32 s36, s34, 13
    s_add_u32 s36, s36, 16384
    v_add_u32 v8, s35, v5
    v_xor_b32 v9, 64, v5
    v_add_u32 v9, s35, v9
    v_add_u32 v10, s36, v3
    v_add_u32 v11, s35, v5
    v_xor_b32 v12, 64, v5
    v_add_u32 v12, s35, v12
    v_add_u32 v13, s36, v3
    v_add_u32 v11, 65536, v11
    v_add_u32 v12, 65536, v12
    v_add_u32 v13, 65536, v13
    v_add_u32 v14, s35, v5
    v_xor_b32 v15, 64, v5
    v_add_u32 v15, s35, v15
    v_add_u32 v16, s36, v3
    v_add_u32 v14, 131072, v14
    v_add_u32 v15, 131072, v15
    v_add_u32 v16, 131072, v16
    v_mov_b32 v64, 0
    v_mov_b32 v65, 0
    v_mov_b32 v66, 0
    v_mov_b32 v67, 0
    v_mov_b32 v68, 0
    v_mov_b32 v69, 0
    v_mov_b32 v70, 0
    v_mov_b32 v71, 0
    v_mov_b32 v72, 0
    v_mov_b32 v73, 0
    v_mov_b32 v74, 0
    v_mov_b32 v75, 0
    v_mov_b32 v76, 0
    v_mov_b32 v77, 0
    v_mov_b32 v78, 0
    v_mov_b32 v79, 0
    v_mov_b32 v80, 0
    v_mov_b32 v81, 0
    v_mov_b32 v82, 0
    v_mov_b32 v83, 0
    v_mov_b32 v84, 0
    v_mov_b32 v85, 0
    v_mov_b32 v86, 0
    v_mov_b32 v87, 0
    v_mov_b32 v88, 0
    v_mov_b32 v89, 0
    v_mov_b32 v90, 0
    v_mov_b32 v91, 0
    v_mov_b32 v92, 0
    v_mov_b32 v93, 0
    v_mov_b32 v94, 0
    v_mov_b32 v95, 0
    v_mov_b32 v96, 0
    v_mov_b32 v97, 0
    v_mov_b32 v98, 0
    v_mov_b32 v99, 0
    v_mov_b32 v100, 0
    v_mov_b32 v101, 0
    v_mov_b32 v102, 0
    v_mov_b32 v103, 0
    v_mov_b32 v104, 0
    v_mov_b32 v105, 0
    v_mov_b32 v106, 0
    v_mov_b32 v107, 0
    v_mov_b32 v108, 0
    v_mov_b32 v109, 0
    v_mov_b32 v110, 0
    v_mov_b32 v111, 0
    v_mov_b32 v112, 0
    v_mov_b32 v113, 0
    v_mov_b32 v114, 0
    v_mov_b32 v115, 0
    v_mov_b32 v116, 0
    v_mov_b32 v117, 0
    v_mov_b32 v118, 0
    v_mov_b32 v119, 0
    v_mov_b32 v120, 0
    v_mov_b32 v121, 0
    v_mov_b32 v122, 0
    v_mov_b32 v123, 0
    v_mov_b32 v124, 0
    v_mov_b32 v125, 0
    v_mov_b32 v126, 0
    v_mov_b32 v127, 0
    s_waitcnt lgkmcnt(0)
    s_mov_b32 s16, s8
    s_and_b32 s17, s9, 0xffff
    s_mov_b32 s18, 16777216
    s_mov_b32 s19, 0x00020000
    v_mov_b32 v198, 0
    s_mov_b32 s20, s10
    s_and_b32 s21, s11, 0xffff
    s_mov_b32 s22, 256
    s_mov_b32 s23, 0x00020000
    buffer_load_dword v199, v198, s[20:23], 0 offen sc1
    s_barrier
    ds_read_b128 v[144:147], v13 offset:32768
    ds_read_b128 v[128:131], v11 offset:32768
    ds_read_b128 v[148:151], v13 offset:34816
    ds_read_b128 v[132:135], v11 offset:34816
    ds_read_b128 v[152:155], v13 offset:36864
    ds_read_b128 v[136:139], v11 offset:36864
    ds_read_b128 v[156:159], v13 offset:38912
    ds_read_b128 v[140:143], v11 offset:38912
    s_waitcnt lgkmcnt(0)
    v_mfma_f32_16x16x32_bf16 v[64:67], v[144:147], v[128:131], v[64:67]
    ds_read_b128 v[176:179], v13 offset:33792
    v_mfma_f32_16x16x32_bf16 v[68:71], v[144:147], v[132:135], v[68:71]
    ds_read_b128 v[160:163], v12 offset:32768
    v_mfma_f32_16x16x32_bf16 v[72:75], v[144:147], v[136:139], v[72:75]
    ds_read_b128 v[180:183], v13 offset:35840
    v_mfma_f32_16x16x32_bf16 v[76:79], v[144:147], v[140:143], v[76:79]
    ds_read_b128 v[164:167], v12 offset:34816
    v_mfma_f32_16x16x32_bf16 v[80:83], v[148:151], v[128:131], v[80:83]
    ds_read_b128 v[184:187], v13 offset:37888
    v_mfma_f32_16x16x32_bf16 v[84:87], v[148:151], v[132:135], v[84:87]
    ds_read_b128 v[168:171], v12 offset:36864
    v_mfma_f32_16x16x32_bf16 v[88:91], v[148:151], v[136:139], v[88:91]
    ds_read_b128 v[188:191], v13 offset:39936
    v_mfma_f32_16x16x32_bf16 v[92:95], v[148:151], v[140:143], v[92:95]
    ds_read_b128 v[172:175], v12 offset:38912
    v_mfma_f32_16x16x32_bf16 v[96:99], v[152:155], v[128:131], v[96:99]
    v_mfma_f32_16x16x32_bf16 v[100:103], v[152:155], v[132:135], v[100:103]
    v_mfma_f32_16x16x32_bf16 v[104:107], v[152:155], v[136:139], v[104:107]
    v_mfma_f32_16x16x32_bf16 v[108:111], v[152:155], v[140:143], v[108:111]
    v_mfma_f32_16x16x32_bf16 v[112:115], v[156:159], v[128:131], v[112:115]
    v_mfma_f32_16x16x32_bf16 v[116:119], v[156:159], v[132:135], v[116:119]
    v_mfma_f32_16x16x32_bf16 v[120:123], v[156:159], v[136:139], v[120:123]
    v_mfma_f32_16x16x32_bf16 v[124:127], v[156:159], v[140:143], v[124:127]
    s_waitcnt lgkmcnt(0)
    v_mfma_f32_16x16x32_bf16 v[64:67], v[176:179], v[160:163], v[64:67]
    s_barrier
    ds_read_b128 v[144:147], v16 offset:0
    v_mfma_f32_16x16x32_bf16 v[68:71], v[176:179], v[164:167], v[68:71]
    ds_read_b128 v[128:131], v14 offset:0
    v_mfma_f32_16x16x32_bf16 v[72:75], v[176:179], v[168:171], v[72:75]
    ds_read_b128 v[148:151], v16 offset:2048
    v_mfma_f32_16x16x32_bf16 v[76:79], v[176:179], v[172:175], v[76:79]
    ds_read_b128 v[132:135], v14 offset:2048
    v_mfma_f32_16x16x32_bf16 v[80:83], v[180:183], v[160:163], v[80:83]
    ds_read_b128 v[152:155], v16 offset:4096
    v_mfma_f32_16x16x32_bf16 v[84:87], v[180:183], v[164:167], v[84:87]
    ds_read_b128 v[136:139], v14 offset:4096
    v_mfma_f32_16x16x32_bf16 v[88:91], v[180:183], v[168:171], v[88:91]
    ds_read_b128 v[156:159], v16 offset:6144
    v_mfma_f32_16x16x32_bf16 v[92:95], v[180:183], v[172:175], v[92:95]
    ds_read_b128 v[140:143], v14 offset:6144
    v_mfma_f32_16x16x32_bf16 v[96:99], v[184:187], v[160:163], v[96:99]
    v_mfma_f32_16x16x32_bf16 v[100:103], v[184:187], v[164:167], v[100:103]
    v_mfma_f32_16x16x32_bf16 v[104:107], v[184:187], v[168:171], v[104:107]
    v_mfma_f32_16x16x32_bf16 v[108:111], v[184:187], v[172:175], v[108:111]
    v_mfma_f32_16x16x32_bf16 v[112:115], v[188:191], v[160:163], v[112:115]
    v_mfma_f32_16x16x32_bf16 v[116:119], v[188:191], v[164:167], v[116:119]
    v_mfma_f32_16x16x32_bf16 v[120:123], v[188:191], v[168:171], v[120:123]
    v_mfma_f32_16x16x32_bf16 v[124:127], v[188:191], v[172:175], v[124:127]
    s_waitcnt lgkmcnt(0)
    v_mfma_f32_16x16x32_bf16 v[64:67], v[144:147], v[128:131], v[64:67]
    ds_read_b128 v[176:179], v16 offset:1024
    v_mfma_f32_16x16x32_bf16 v[68:71], v[144:147], v[132:135], v[68:71]
    ds_read_b128 v[160:163], v15 offset:0
    v_mfma_f32_16x16x32_bf16 v[72:75], v[144:147], v[136:139], v[72:75]
    ds_read_b128 v[180:183], v16 offset:3072
    v_mfma_f32_16x16x32_bf16 v[76:79], v[144:147], v[140:143], v[76:79]
    ds_read_b128 v[164:167], v15 offset:2048
    v_mfma_f32_16x16x32_bf16 v[80:83], v[148:151], v[128:131], v[80:83]
    ds_read_b128 v[184:187], v16 offset:5120
    v_mfma_f32_16x16x32_bf16 v[84:87], v[148:151], v[132:135], v[84:87]
    ds_read_b128 v[168:171], v15 offset:4096
    v_mfma_f32_16x16x32_bf16 v[88:91], v[148:151], v[136:139], v[88:91]
    ds_read_b128 v[188:191], v16 offset:7168
    v_mfma_f32_16x16x32_bf16 v[92:95], v[148:151], v[140:143], v[92:95]
    ds_read_b128 v[172:175], v15 offset:6144
    v_mfma_f32_16x16x32_bf16 v[96:99], v[152:155], v[128:131], v[96:99]
    v_mfma_f32_16x16x32_bf16 v[100:103], v[152:155], v[132:135], v[100:103]
    v_mfma_f32_16x16x32_bf16 v[104:107], v[152:155], v[136:139], v[104:107]
    v_mfma_f32_16x16x32_bf16 v[108:111], v[152:155], v[140:143], v[108:111]
    v_mfma_f32_16x16x32_bf16 v[112:115], v[156:159], v[128:131], v[112:115]
    v_mfma_f32_16x16x32_bf16 v[116:119], v[156:159], v[132:135], v[116:119]
    v_mfma_f32_16x16x32_bf16 v[120:123], v[156:159], v[136:139], v[120:123]
    v_mfma_f32_16x16x32_bf16 v[124:127], v[156:159], v[140:143], v[124:127]
    s_waitcnt lgkmcnt(0)
    v_mfma_f32_16x16x32_bf16 v[64:67], v[176:179], v[160:163], v[64:67]
    s_barrier
    ds_read_b128 v[144:147], v10 offset:0
    v_mfma_f32_16x16x32_bf16 v[68:71], v[176:179], v[164:167], v[68:71]
    ds_read_b128 v[128:131], v8 offset:0
    v_mfma_f32_16x16x32_bf16 v[72:75], v[176:179], v[168:171], v[72:75]
    ds_read_b128 v[148:151], v10 offset:2048
    v_mfma_f32_16x16x32_bf16 v[76:79], v[176:179], v[172:175], v[76:79]
    ds_read_b128 v[132:135], v8 offset:2048
    v_mfma_f32_16x16x32_bf16 v[80:83], v[180:183], v[160:163], v[80:83]
    ds_read_b128 v[152:155], v10 offset:4096
    v_mfma_f32_16x16x32_bf16 v[84:87], v[180:183], v[164:167], v[84:87]
    ds_read_b128 v[136:139], v8 offset:4096
    v_mfma_f32_16x16x32_bf16 v[88:91], v[180:183], v[168:171], v[88:91]
    ds_read_b128 v[156:159], v10 offset:6144
    v_mfma_f32_16x16x32_bf16 v[92:95], v[180:183], v[172:175], v[92:95]
    ds_read_b128 v[140:143], v8 offset:6144
    v_mfma_f32_16x16x32_bf16 v[96:99], v[184:187], v[160:163], v[96:99]
    v_mfma_f32_16x16x32_bf16 v[100:103], v[184:187], v[164:167], v[100:103]
    v_mfma_f32_16x16x32_bf16 v[104:107], v[184:187], v[168:171], v[104:107]
    v_mfma_f32_16x16x32_bf16 v[108:111], v[184:187], v[172:175], v[108:111]
    v_mfma_f32_16x16x32_bf16 v[112:115], v[188:191], v[160:163], v[112:115]
    v_mfma_f32_16x16x32_bf16 v[116:119], v[188:191], v[164:167], v[116:119]
    v_mfma_f32_16x16x32_bf16 v[120:123], v[188:191], v[168:171], v[120:123]
    v_mfma_f32_16x16x32_bf16 v[124:127], v[188:191], v[172:175], v[124:127]
    s_waitcnt lgkmcnt(0)
    v_mfma_f32_16x16x32_bf16 v[64:67], v[144:147], v[128:131], v[64:67]
    ds_read_b128 v[176:179], v10 offset:1024
    v_mfma_f32_16x16x32_bf16 v[68:71], v[144:147], v[132:135], v[68:71]
    ds_read_b128 v[160:163], v9 offset:0
    v_mfma_f32_16x16x32_bf16 v[72:75], v[144:147], v[136:139], v[72:75]
    ds_read_b128 v[180:183], v10 offset:3072
    v_mfma_f32_16x16x32_bf16 v[76:79], v[144:147], v[140:143], v[76:79]
    ds_read_b128 v[164:167], v9 offset:2048
    v_mfma_f32_16x16x32_bf16 v[80:83], v[148:151], v[128:131], v[80:83]
    ds_read_b128 v[184:187], v10 offset:5120
    v_mfma_f32_16x16x32_bf16 v[84:87], v[148:151], v[132:135], v[84:87]
    ds_read_b128 v[168:171], v9 offset:4096
    v_mfma_f32_16x16x32_bf16 v[88:91], v[148:151], v[136:139], v[88:91]
    ds_read_b128 v[188:191], v10 offset:7168
    v_mfma_f32_16x16x32_bf16 v[92:95], v[148:151], v[140:143], v[92:95]
    ds_read_b128 v[172:175], v9 offset:6144
    v_mfma_f32_16x16x32_bf16 v[96:99], v[152:155], v[128:131], v[96:99]
    v_mfma_f32_16x16x32_bf16 v[100:103], v[152:155], v[132:135], v[100:103]
    v_mfma_f32_16x16x32_bf16 v[104:107], v[152:155], v[136:139], v[104:107]
    v_mfma_f32_16x16x32_bf16 v[108:111], v[152:155], v[140:143], v[108:111]
    v_mfma_f32_16x16x32_bf16 v[112:115], v[156:159], v[128:131], v[112:115]
    v_mfma_f32_16x16x32_bf16 v[116:119], v[156:159], v[132:135], v[116:119]
    v_mfma_f32_16x16x32_bf16 v[120:123], v[156:159], v[136:139], v[120:123]
    v_mfma_f32_16x16x32_bf16 v[124:127], v[156:159], v[140:143], v[124:127]
    s_waitcnt lgkmcnt(0)
    v_mfma_f32_16x16x32_bf16 v[64:67], v[176:179], v[160:163], v[64:67]
    s_barrier
    ds_read_b128 v[144:147], v10 offset:32768
    v_mfma_f32_16x16x32_bf16 v[68:71], v[176:179], v[164:167], v[68:71]
    ds_read_b128 v[128:131], v8 offset:32768
    v_mfma_f32_16x16x32_bf16 v[72:75], v[176:179], v[168:171], v[72:75]
    ds_read_b128 v[148:151], v10 offset:34816
    v_mfma_f32_16x16x32_bf16 v[76:79], v[176:179], v[172:175], v[76:79]
    ds_read_b128 v[132:135], v8 offset:34816
    v_mfma_f32_16x16x32_bf16 v[80:83], v[180:183], v[160:163], v[80:83]
    ds_read_b128 v[152:155], v10 offset:36864
    v_mfma_f32_16x16x32_bf16 v[84:87], v[180:183], v[164:167], v[84:87]
    ds_read_b128 v[136:139], v8 offset:36864
    v_mfma_f32_16x16x32_bf16 v[88:91], v[180:183], v[168:171], v[88:91]
    ds_read_b128 v[156:159], v10 offset:38912
    v_mfma_f32_16x16x32_bf16 v[92:95], v[180:183], v[172:175], v[92:95]
    ds_read_b128 v[140:143], v8 offset:38912
    v_mfma_f32_16x16x32_bf16 v[96:99], v[184:187], v[160:163], v[96:99]
    v_mfma_f32_16x16x32_bf16 v[100:103], v[184:187], v[164:167], v[100:103]
    v_mfma_f32_16x16x32_bf16 v[104:107], v[184:187], v[168:171], v[104:107]
    v_mfma_f32_16x16x32_bf16 v[108:111], v[184:187], v[172:175], v[108:111]
    v_mfma_f32_16x16x32_bf16 v[112:115], v[188:191], v[160:163], v[112:115]
    v_mfma_f32_16x16x32_bf16 v[116:119], v[188:191], v[164:167], v[116:119]
    v_mfma_f32_16x16x32_bf16 v[120:123], v[188:191], v[168:171], v[120:123]
    v_mfma_f32_16x16x32_bf16 v[124:127], v[188:191], v[172:175], v[124:127]
    s_waitcnt lgkmcnt(0)
    v_mfma_f32_16x16x32_bf16 v[64:67], v[144:147], v[128:131], v[64:67]
    ds_read_b128 v[176:179], v10 offset:33792
    v_mfma_f32_16x16x32_bf16 v[68:71], v[144:147], v[132:135], v[68:71]
    ds_read_b128 v[160:163], v9 offset:32768
    v_mfma_f32_16x16x32_bf16 v[72:75], v[144:147], v[136:139], v[72:75]
    ds_read_b128 v[180:183], v10 offset:35840
    v_mfma_f32_16x16x32_bf16 v[76:79], v[144:147], v[140:143], v[76:79]
    ds_read_b128 v[164:167], v9 offset:34816
    v_mfma_f32_16x16x32_bf16 v[80:83], v[148:151], v[128:131], v[80:83]
    ds_read_b128 v[184:187], v10 offset:37888
    v_mfma_f32_16x16x32_bf16 v[84:87], v[148:151], v[132:135], v[84:87]
    ds_read_b128 v[168:171], v9 offset:36864
    v_mfma_f32_16x16x32_bf16 v[88:91], v[148:151], v[136:139], v[88:91]
    ds_read_b128 v[188:191], v10 offset:39936
    v_mfma_f32_16x16x32_bf16 v[92:95], v[148:151], v[140:143], v[92:95]
    ds_read_b128 v[172:175], v9 offset:38912
    v_mfma_f32_16x16x32_bf16 v[96:99], v[152:155], v[128:131], v[96:99]
    v_mfma_f32_16x16x32_bf16 v[100:103], v[152:155], v[132:135], v[100:103]
    v_mfma_f32_16x16x32_bf16 v[104:107], v[152:155], v[136:139], v[104:107]
    v_mfma_f32_16x16x32_bf16 v[108:111], v[152:155], v[140:143], v[108:111]
    v_mfma_f32_16x16x32_bf16 v[112:115], v[156:159], v[128:131], v[112:115]
    v_mfma_f32_16x16x32_bf16 v[116:119], v[156:159], v[132:135], v[116:119]
    v_mfma_f32_16x16x32_bf16 v[120:123], v[156:159], v[136:139], v[120:123]
    v_mfma_f32_16x16x32_bf16 v[124:127], v[156:159], v[140:143], v[124:127]
    s_waitcnt lgkmcnt(0)
    v_mfma_f32_16x16x32_bf16 v[64:67], v[176:179], v[160:163], v[64:67]
    s_barrier
    ds_read_b128 v[144:147], v13 offset:0
    v_mfma_f32_16x16x32_bf16 v[68:71], v[176:179], v[164:167], v[68:71]
    ds_read_b128 v[128:131], v11 offset:0
    v_mfma_f32_16x16x32_bf16 v[72:75], v[176:179], v[168:171], v[72:75]
    ds_read_b128 v[148:151], v13 offset:2048
    v_mfma_f32_16x16x32_bf16 v[76:79], v[176:179], v[172:175], v[76:79]
    ds_read_b128 v[132:135], v11 offset:2048
    v_mfma_f32_16x16x32_bf16 v[80:83], v[180:183], v[160:163], v[80:83]
    ds_read_b128 v[152:155], v13 offset:4096
    v_mfma_f32_16x16x32_bf16 v[84:87], v[180:183], v[164:167], v[84:87]
    ds_read_b128 v[136:139], v11 offset:4096
    v_mfma_f32_16x16x32_bf16 v[88:91], v[180:183], v[168:171], v[88:91]
    ds_read_b128 v[156:159], v13 offset:6144
    v_mfma_f32_16x16x32_bf16 v[92:95], v[180:183], v[172:175], v[92:95]
    ds_read_b128 v[140:143], v11 offset:6144
    v_mfma_f32_16x16x32_bf16 v[96:99], v[184:187], v[160:163], v[96:99]
    v_mfma_f32_16x16x32_bf16 v[100:103], v[184:187], v[164:167], v[100:103]
    v_mfma_f32_16x16x32_bf16 v[104:107], v[184:187], v[168:171], v[104:107]
    v_mfma_f32_16x16x32_bf16 v[108:111], v[184:187], v[172:175], v[108:111]
    v_mfma_f32_16x16x32_bf16 v[112:115], v[188:191], v[160:163], v[112:115]
    v_mfma_f32_16x16x32_bf16 v[116:119], v[188:191], v[164:167], v[116:119]
    v_mfma_f32_16x16x32_bf16 v[120:123], v[188:191], v[168:171], v[120:123]
    v_mfma_f32_16x16x32_bf16 v[124:127], v[188:191], v[172:175], v[124:127]
    s_waitcnt lgkmcnt(0)
    v_mfma_f32_16x16x32_bf16 v[64:67], v[144:147], v[128:131], v[64:67]
    ds_read_b128 v[176:179], v13 offset:1024
    v_mfma_f32_16x16x32_bf16 v[68:71], v[144:147], v[132:135], v[68:71]
    ds_read_b128 v[160:163], v12 offset:0
    v_mfma_f32_16x16x32_bf16 v[72:75], v[144:147], v[136:139], v[72:75]
    ds_read_b128 v[180:183], v13 offset:3072
    v_mfma_f32_16x16x32_bf16 v[76:79], v[144:147], v[140:143], v[76:79]
    ds_read_b128 v[164:167], v12 offset:2048
    v_mfma_f32_16x16x32_bf16 v[80:83], v[148:151], v[128:131], v[80:83]
    ds_read_b128 v[184:187], v13 offset:5120
    v_mfma_f32_16x16x32_bf16 v[84:87], v[148:151], v[132:135], v[84:87]
    ds_read_b128 v[168:171], v12 offset:4096
    v_mfma_f32_16x16x32_bf16 v[88:91], v[148:151], v[136:139], v[88:91]
    ds_read_b128 v[188:191], v13 offset:7168
    v_mfma_f32_16x16x32_bf16 v[92:95], v[148:151], v[140:143], v[92:95]
    ds_read_b128 v[172:175], v12 offset:6144
    v_mfma_f32_16x16x32_bf16 v[96:99], v[152:155], v[128:131], v[96:99]
    v_mfma_f32_16x16x32_bf16 v[100:103], v[152:155], v[132:135], v[100:103]
    v_mfma_f32_16x16x32_bf16 v[104:107], v[152:155], v[136:139], v[104:107]
    v_mfma_f32_16x16x32_bf16 v[108:111], v[152:155], v[140:143], v[108:111]
    v_mfma_f32_16x16x32_bf16 v[112:115], v[156:159], v[128:131], v[112:115]
    v_mfma_f32_16x16x32_bf16 v[116:119], v[156:159], v[132:135], v[116:119]
    v_mfma_f32_16x16x32_bf16 v[120:123], v[156:159], v[136:139], v[120:123]
    v_mfma_f32_16x16x32_bf16 v[124:127], v[156:159], v[140:143], v[124:127]
    s_waitcnt lgkmcnt(0)
    v_mfma_f32_16x16x32_bf16 v[64:67], v[176:179], v[160:163], v[64:67]
    s_barrier
    ds_read_b128 v[144:147], v13 offset:32768
    v_mfma_f32_16x16x32_bf16 v[68:71], v[176:179], v[164:167], v[68:71]
    ds_read_b128 v[128:131], v11 offset:32768
    v_mfma_f32_16x16x32_bf16 v[72:75], v[176:179], v[168:171], v[72:75]
    ds_read_b128 v[148:151], v13 offset:34816
    v_mfma_f32_16x16x32_bf16 v[76:79], v[176:179], v[172:175], v[76:79]
    ds_read_b128 v[132:135], v11 offset:34816
    v_mfma_f32_16x16x32_bf16 v[80:83], v[180:183], v[160:163], v[80:83]
    ds_read_b128 v[152:155], v13 offset:36864
    v_mfma_f32_16x16x32_bf16 v[84:87], v[180:183], v[164:167], v[84:87]
    ds_read_b128 v[136:139], v11 offset:36864
    v_mfma_f32_16x16x32_bf16 v[88:91], v[180:183], v[168:171], v[88:91]
    ds_read_b128 v[156:159], v13 offset:38912
    v_mfma_f32_16x16x32_bf16 v[92:95], v[180:183], v[172:175], v[92:95]
    ds_read_b128 v[140:143], v11 offset:38912
    v_mfma_f32_16x16x32_bf16 v[96:99], v[184:187], v[160:163], v[96:99]
    v_mfma_f32_16x16x32_bf16 v[100:103], v[184:187], v[164:167], v[100:103]
    v_mfma_f32_16x16x32_bf16 v[104:107], v[184:187], v[168:171], v[104:107]
    v_mfma_f32_16x16x32_bf16 v[108:111], v[184:187], v[172:175], v[108:111]
    v_mfma_f32_16x16x32_bf16 v[112:115], v[188:191], v[160:163], v[112:115]
    v_mfma_f32_16x16x32_bf16 v[116:119], v[188:191], v[164:167], v[116:119]
    v_mfma_f32_16x16x32_bf16 v[120:123], v[188:191], v[168:171], v[120:123]
    v_mfma_f32_16x16x32_bf16 v[124:127], v[188:191], v[172:175], v[124:127]
    s_waitcnt lgkmcnt(0)
    v_mfma_f32_16x16x32_bf16 v[64:67], v[144:147], v[128:131], v[64:67]
    ds_read_b128 v[176:179], v13 offset:33792
    v_mfma_f32_16x16x32_bf16 v[68:71], v[144:147], v[132:135], v[68:71]
    ds_read_b128 v[160:163], v12 offset:32768
    v_mfma_f32_16x16x32_bf16 v[72:75], v[144:147], v[136:139], v[72:75]
    ds_read_b128 v[180:183], v13 offset:35840
    v_mfma_f32_16x16x32_bf16 v[76:79], v[144:147], v[140:143], v[76:79]
    ds_read_b128 v[164:167], v12 offset:34816
    v_mfma_f32_16x16x32_bf16 v[80:83], v[148:151], v[128:131], v[80:83]
    ds_read_b128 v[184:187], v13 offset:37888
    v_mfma_f32_16x16x32_bf16 v[84:87], v[148:151], v[132:135], v[84:87]
    ds_read_b128 v[168:171], v12 offset:36864
    v_mfma_f32_16x16x32_bf16 v[88:91], v[148:151], v[136:139], v[88:91]
    ds_read_b128 v[188:191], v13 offset:39936
    v_mfma_f32_16x16x32_bf16 v[92:95], v[148:151], v[140:143], v[92:95]
    ds_read_b128 v[172:175], v12 offset:38912
    v_mfma_f32_16x16x32_bf16 v[96:99], v[152:155], v[128:131], v[96:99]
    v_mfma_f32_16x16x32_bf16 v[100:103], v[152:155], v[132:135], v[100:103]
    v_mfma_f32_16x16x32_bf16 v[104:107], v[152:155], v[136:139], v[104:107]
    v_mfma_f32_16x16x32_bf16 v[108:111], v[152:155], v[140:143], v[108:111]
    v_mfma_f32_16x16x32_bf16 v[112:115], v[156:159], v[128:131], v[112:115]
    v_mfma_f32_16x16x32_bf16 v[116:119], v[156:159], v[132:135], v[116:119]
    v_mfma_f32_16x16x32_bf16 v[120:123], v[156:159], v[136:139], v[120:123]
    v_mfma_f32_16x16x32_bf16 v[124:127], v[156:159], v[140:143], v[124:127]
    s_waitcnt lgkmcnt(0)
    v_mfma_f32_16x16x32_bf16 v[64:67], v[176:179], v[160:163], v[64:67]
    s_barrier
    ds_read_b128 v[144:147], v16 offset:0
    v_mfma_f32_16x16x32_bf16 v[68:71], v[176:179], v[164:167], v[68:71]
    ds_read_b128 v[128:131], v14 offset:0
    v_mfma_f32_16x16x32_bf16 v[72:75], v[176:179], v[168:171], v[72:75]
    ds_read_b128 v[148:151], v16 offset:2048
    v_mfma_f32_16x16x32_bf16 v[76:79], v[176:179], v[172:175], v[76:79]
    ds_read_b128 v[132:135], v14 offset:2048
    v_mfma_f32_16x16x32_bf16 v[80:83], v[180:183], v[160:163], v[80:83]
    ds_read_b128 v[152:155], v16 offset:4096
    v_mfma_f32_16x16x32_bf16 v[84:87], v[180:183], v[164:167], v[84:87]
    ds_read_b128 v[136:139], v14 offset:4096
    v_mfma_f32_16x16x32_bf16 v[88:91], v[180:183], v[168:171], v[88:91]
    ds_read_b128 v[156:159], v16 offset:6144
    v_mfma_f32_16x16x32_bf16 v[92:95], v[180:183], v[172:175], v[92:95]
    ds_read_b128 v[140:143], v14 offset:6144
    v_mfma_f32_16x16x32_bf16 v[96:99], v[184:187], v[160:163], v[96:99]
    v_mfma_f32_16x16x32_bf16 v[100:103], v[184:187], v[164:167], v[100:103]
    v_mfma_f32_16x16x32_bf16 v[104:107], v[184:187], v[168:171], v[104:107]
    v_mfma_f32_16x16x32_bf16 v[108:111], v[184:187], v[172:175], v[108:111]
    v_mfma_f32_16x16x32_bf16 v[112:115], v[188:191], v[160:163], v[112:115]
    v_mfma_f32_16x16x32_bf16 v[116:119], v[188:191], v[164:167], v[116:119]
    v_mfma_f32_16x16x32_bf16 v[120:123], v[188:191], v[168:171], v[120:123]
    v_mfma_f32_16x16x32_bf16 v[124:127], v[188:191], v[172:175], v[124:127]
    s_waitcnt lgkmcnt(0)
    v_mfma_f32_16x16x32_bf16 v[64:67], v[144:147], v[128:131], v[64:67]
    ds_read_b128 v[176:179], v16 offset:1024
    v_mfma_f32_16x16x32_bf16 v[68:71], v[144:147], v[132:135], v[68:71]
    ds_read_b128 v[160:163], v15 offset:0
    v_mfma_f32_16x16x32_bf16 v[72:75], v[144:147], v[136:139], v[72:75]
    ds_read_b128 v[180:183], v16 offset:3072
    v_mfma_f32_16x16x32_bf16 v[76:79], v[144:147], v[140:143], v[76:79]
    ds_read_b128 v[164:167], v15 offset:2048
    v_mfma_f32_16x16x32_bf16 v[80:83], v[148:151], v[128:131], v[80:83]
    ds_read_b128 v[184:187], v16 offset:5120
    v_mfma_f32_16x16x32_bf16 v[84:87], v[148:151], v[132:135], v[84:87]
    ds_read_b128 v[168:171], v15 offset:4096
    v_mfma_f32_16x16x32_bf16 v[88:91], v[148:151], v[136:139], v[88:91]
    ds_read_b128 v[188:191], v16 offset:7168
    v_mfma_f32_16x16x32_bf16 v[92:95], v[148:151], v[140:143], v[92:95]
    ds_read_b128 v[172:175], v15 offset:6144
    v_mfma_f32_16x16x32_bf16 v[96:99], v[152:155], v[128:131], v[96:99]
    v_mfma_f32_16x16x32_bf16 v[100:103], v[152:155], v[132:135], v[100:103]
    v_mfma_f32_16x16x32_bf16 v[104:107], v[152:155], v[136:139], v[104:107]
    v_mfma_f32_16x16x32_bf16 v[108:111], v[152:155], v[140:143], v[108:111]
    v_mfma_f32_16x16x32_bf16 v[112:115], v[156:159], v[128:131], v[112:115]
    v_mfma_f32_16x16x32_bf16 v[116:119], v[156:159], v[132:135], v[116:119]
    v_mfma_f32_16x16x32_bf16 v[120:123], v[156:159], v[136:139], v[120:123]
    v_mfma_f32_16x16x32_bf16 v[124:127], v[156:159], v[140:143], v[124:127]
    s_waitcnt lgkmcnt(0)
    v_mfma_f32_16x16x32_bf16 v[64:67], v[176:179], v[160:163], v[64:67]
    s_barrier
    ds_read_b128 v[144:147], v10 offset:0
    v_mfma_f32_16x16x32_bf16 v[68:71], v[176:179], v[164:167], v[68:71]
    ds_read_b128 v[128:131], v8 offset:0
    v_mfma_f32_16x16x32_bf16 v[72:75], v[176:179], v[168:171], v[72:75]
    ds_read_b128 v[148:151], v10 offset:2048
    v_mfma_f32_16x16x32_bf16 v[76:79], v[176:179], v[172:175], v[76:79]
    ds_read_b128 v[132:135], v8 offset:2048
    v_mfma_f32_16x16x32_bf16 v[80:83], v[180:183], v[160:163], v[80:83]
    ds_read_b128 v[152:155], v10 offset:4096
    v_mfma_f32_16x16x32_bf16 v[84:87], v[180:183], v[164:167], v[84:87]
    ds_read_b128 v[136:139], v8 offset:4096
    v_mfma_f32_16x16x32_bf16 v[88:91], v[180:183], v[168:171], v[88:91]
    ds_read_b128 v[156:159], v10 offset:6144
    v_mfma_f32_16x16x32_bf16 v[92:95], v[180:183], v[172:175], v[92:95]
    ds_read_b128 v[140:143], v8 offset:6144
    v_mfma_f32_16x16x32_bf16 v[96:99], v[184:187], v[160:163], v[96:99]
    v_mfma_f32_16x16x32_bf16 v[100:103], v[184:187], v[164:167], v[100:103]
    v_mfma_f32_16x16x32_bf16 v[104:107], v[184:187], v[168:171], v[104:107]
    v_mfma_f32_16x16x32_bf16 v[108:111], v[184:187], v[172:175], v[108:111]
    v_mfma_f32_16x16x32_bf16 v[112:115], v[188:191], v[160:163], v[112:115]
    v_mfma_f32_16x16x32_bf16 v[116:119], v[188:191], v[164:167], v[116:119]
    v_mfma_f32_16x16x32_bf16 v[120:123], v[188:191], v[168:171], v[120:123]
    v_mfma_f32_16x16x32_bf16 v[124:127], v[188:191], v[172:175], v[124:127]
    s_waitcnt lgkmcnt(0)
    v_mfma_f32_16x16x32_bf16 v[64:67], v[144:147], v[128:131], v[64:67]
    ds_read_b128 v[176:179], v10 offset:1024
    v_mfma_f32_16x16x32_bf16 v[68:71], v[144:147], v[132:135], v[68:71]
    ds_read_b128 v[160:163], v9 offset:0
    v_mfma_f32_16x16x32_bf16 v[72:75], v[144:147], v[136:139], v[72:75]
    ds_read_b128 v[180:183], v10 offset:3072
    v_mfma_f32_16x16x32_bf16 v[76:79], v[144:147], v[140:143], v[76:79]
    ds_read_b128 v[164:167], v9 offset:2048
    v_mfma_f32_16x16x32_bf16 v[80:83], v[148:151], v[128:131], v[80:83]
    ds_read_b128 v[184:187], v10 offset:5120
    v_mfma_f32_16x16x32_bf16 v[84:87], v[148:151], v[132:135], v[84:87]
    ds_read_b128 v[168:171], v9 offset:4096
    v_mfma_f32_16x16x32_bf16 v[88:91], v[148:151], v[136:139], v[88:91]
    ds_read_b128 v[188:191], v10 offset:7168
    v_mfma_f32_16x16x32_bf16 v[92:95], v[148:151], v[140:143], v[92:95]
    ds_read_b128 v[172:175], v9 offset:6144
    v_mfma_f32_16x16x32_bf16 v[96:99], v[152:155], v[128:131], v[96:99]
    v_mfma_f32_16x16x32_bf16 v[100:103], v[152:155], v[132:135], v[100:103]
    v_mfma_f32_16x16x32_bf16 v[104:107], v[152:155], v[136:139], v[104:107]
    v_mfma_f32_16x16x32_bf16 v[108:111], v[152:155], v[140:143], v[108:111]
    v_mfma_f32_16x16x32_bf16 v[112:115], v[156:159], v[128:131], v[112:115]
    v_mfma_f32_16x16x32_bf16 v[116:119], v[156:159], v[132:135], v[116:119]
    v_mfma_f32_16x16x32_bf16 v[120:123], v[156:159], v[136:139], v[120:123]
    v_mfma_f32_16x16x32_bf16 v[124:127], v[156:159], v[140:143], v[124:127]
    s_waitcnt lgkmcnt(0)
    v_mfma_f32_16x16x32_bf16 v[64:67], v[176:179], v[160:163], v[64:67]
    s_barrier
    ds_read_b128 v[144:147], v10 offset:32768
    v_mfma_f32_16x16x32_bf16 v[68:71], v[176:179], v[164:167], v[68:71]
    ds_read_b128 v[128:131], v8 offset:32768
    v_mfma_f32_16x16x32_bf16 v[72:75], v[176:179], v[168:171], v[72:75]
    ds_read_b128 v[148:151], v10 offset:34816
    v_mfma_f32_16x16x32_bf16 v[76:79], v[176:179], v[172:175], v[76:79]
    ds_read_b128 v[132:135], v8 offset:34816
    v_mfma_f32_16x16x32_bf16 v[80:83], v[180:183], v[160:163], v[80:83]
    ds_read_b128 v[152:155], v10 offset:36864
    v_mfma_f32_16x16x32_bf16 v[84:87], v[180:183], v[164:167], v[84:87]
    ds_read_b128 v[136:139], v8 offset:36864
    v_mfma_f32_16x16x32_bf16 v[88:91], v[180:183], v[168:171], v[88:91]
    ds_read_b128 v[156:159], v10 offset:38912
    v_mfma_f32_16x16x32_bf16 v[92:95], v[180:183], v[172:175], v[92:95]
    ds_read_b128 v[140:143], v8 offset:38912
    v_mfma_f32_16x16x32_bf16 v[96:99], v[184:187], v[160:163], v[96:99]
    v_mfma_f32_16x16x32_bf16 v[100:103], v[184:187], v[164:167], v[100:103]
    v_mfma_f32_16x16x32_bf16 v[104:107], v[184:187], v[168:171], v[104:107]
    v_mfma_f32_16x16x32_bf16 v[108:111], v[184:187], v[172:175], v[108:111]
    v_mfma_f32_16x16x32_bf16 v[112:115], v[188:191], v[160:163], v[112:115]
    v_mfma_f32_16x16x32_bf16 v[116:119], v[188:191], v[164:167], v[116:119]
    v_mfma_f32_16x16x32_bf16 v[120:123], v[188:191], v[168:171], v[120:123]
    v_mfma_f32_16x16x32_bf16 v[124:127], v[188:191], v[172:175], v[124:127]
    s_waitcnt lgkmcnt(0)
    v_mfma_f32_16x16x32_bf16 v[64:67], v[144:147], v[128:131], v[64:67]
    ds_read_b128 v[176:179], v10 offset:33792
    v_mfma_f32_16x16x32_bf16 v[68:71], v[144:147], v[132:135], v[68:71]
    ds_read_b128 v[160:163], v9 offset:32768
    v_mfma_f32_16x16x32_bf16 v[72:75], v[144:147], v[136:139], v[72:75]
    ds_read_b128 v[180:183], v10 offset:35840
    v_mfma_f32_16x16x32_bf16 v[76:79], v[144:147], v[140:143], v[76:79]
    ds_read_b128 v[164:167], v9 offset:34816
    v_mfma_f32_16x16x32_bf16 v[80:83], v[148:151], v[128:131], v[80:83]
    ds_read_b128 v[184:187], v10 offset:37888
    v_mfma_f32_16x16x32_bf16 v[84:87], v[148:151], v[132:135], v[84:87]
    ds_read_b128 v[168:171], v9 offset:36864
    v_mfma_f32_16x16x32_bf16 v[88:91], v[148:151], v[136:139], v[88:91]
    ds_read_b128 v[188:191], v10 offset:39936
    v_mfma_f32_16x16x32_bf16 v[92:95], v[148:151], v[140:143], v[92:95]
    ds_read_b128 v[172:175], v9 offset:38912
    v_mfma_f32_16x16x32_bf16 v[96:99], v[152:155], v[128:131], v[96:99]
    v_mfma_f32_16x16x32_bf16 v[100:103], v[152:155], v[132:135], v[100:103]
    v_mfma_f32_16x16x32_bf16 v[104:107], v[152:155], v[136:139], v[104:107]
    v_mfma_f32_16x16x32_bf16 v[108:111], v[152:155], v[140:143], v[108:111]
    v_mfma_f32_16x16x32_bf16 v[112:115], v[156:159], v[128:131], v[112:115]
    v_mfma_f32_16x16x32_bf16 v[116:119], v[156:159], v[132:135], v[116:119]
    v_mfma_f32_16x16x32_bf16 v[120:123], v[156:159], v[136:139], v[120:123]
    v_mfma_f32_16x16x32_bf16 v[124:127], v[156:159], v[140:143], v[124:127]
    s_waitcnt lgkmcnt(0)
    v_mfma_f32_16x16x32_bf16 v[64:67], v[176:179], v[160:163], v[64:67]
    s_barrier
    ds_read_b128 v[144:147], v13 offset:0
    v_mfma_f32_16x16x32_bf16 v[68:71], v[176:179], v[164:167], v[68:71]
    ds_read_b128 v[128:131], v11 offset:0
    v_mfma_f32_16x16x32_bf16 v[72:75], v[176:179], v[168:171], v[72:75]
    ds_read_b128 v[148:151], v13 offset:2048
    v_mfma_f32_16x16x32_bf16 v[76:79], v[176:179], v[172:175], v[76:79]
    ds_read_b128 v[132:135], v11 offset:2048
    v_mfma_f32_16x16x32_bf16 v[80:83], v[180:183], v[160:163], v[80:83]
    ds_read_b128 v[152:155], v13 offset:4096
    v_mfma_f32_16x16x32_bf16 v[84:87], v[180:183], v[164:167], v[84:87]
    ds_read_b128 v[136:139], v11 offset:4096
    v_mfma_f32_16x16x32_bf16 v[88:91], v[180:183], v[168:171], v[88:91]
    ds_read_b128 v[156:159], v13 offset:6144
    v_mfma_f32_16x16x32_bf16 v[92:95], v[180:183], v[172:175], v[92:95]
    ds_read_b128 v[140:143], v11 offset:6144
    v_mfma_f32_16x16x32_bf16 v[96:99], v[184:187], v[160:163], v[96:99]
    v_mfma_f32_16x16x32_bf16 v[100:103], v[184:187], v[164:167], v[100:103]
    v_mfma_f32_16x16x32_bf16 v[104:107], v[184:187], v[168:171], v[104:107]
    v_mfma_f32_16x16x32_bf16 v[108:111], v[184:187], v[172:175], v[108:111]
    v_mfma_f32_16x16x32_bf16 v[112:115], v[188:191], v[160:163], v[112:115]
    v_mfma_f32_16x16x32_bf16 v[116:119], v[188:191], v[164:167], v[116:119]
    v_mfma_f32_16x16x32_bf16 v[120:123], v[188:191], v[168:171], v[120:123]
    v_mfma_f32_16x16x32_bf16 v[124:127], v[188:191], v[172:175], v[124:127]
    s_waitcnt lgkmcnt(0)
    v_mfma_f32_16x16x32_bf16 v[64:67], v[144:147], v[128:131], v[64:67]
    ds_read_b128 v[176:179], v13 offset:1024
    v_mfma_f32_16x16x32_bf16 v[68:71], v[144:147], v[132:135], v[68:71]
    ds_read_b128 v[160:163], v12 offset:0
    v_mfma_f32_16x16x32_bf16 v[72:75], v[144:147], v[136:139], v[72:75]
    ds_read_b128 v[180:183], v13 offset:3072
    v_mfma_f32_16x16x32_bf16 v[76:79], v[144:147], v[140:143], v[76:79]
    ds_read_b128 v[164:167], v12 offset:2048
    v_mfma_f32_16x16x32_bf16 v[80:83], v[148:151], v[128:131], v[80:83]
    ds_read_b128 v[184:187], v13 offset:5120
    v_mfma_f32_16x16x32_bf16 v[84:87], v[148:151], v[132:135], v[84:87]
    ds_read_b128 v[168:171], v12 offset:4096
    v_mfma_f32_16x16x32_bf16 v[88:91], v[148:151], v[136:139], v[88:91]
    ds_read_b128 v[188:191], v13 offset:7168
    v_mfma_f32_16x16x32_bf16 v[92:95], v[148:151], v[140:143], v[92:95]
    ds_read_b128 v[172:175], v12 offset:6144
    v_mfma_f32_16x16x32_bf16 v[96:99], v[152:155], v[128:131], v[96:99]
    v_mfma_f32_16x16x32_bf16 v[100:103], v[152:155], v[132:135], v[100:103]
    v_mfma_f32_16x16x32_bf16 v[104:107], v[152:155], v[136:139], v[104:107]
    v_mfma_f32_16x16x32_bf16 v[108:111], v[152:155], v[140:143], v[108:111]
    v_mfma_f32_16x16x32_bf16 v[112:115], v[156:159], v[128:131], v[112:115]
    v_mfma_f32_16x16x32_bf16 v[116:119], v[156:159], v[132:135], v[116:119]
    v_mfma_f32_16x16x32_bf16 v[120:123], v[156:159], v[136:139], v[120:123]
    v_mfma_f32_16x16x32_bf16 v[124:127], v[156:159], v[140:143], v[124:127]
    s_waitcnt lgkmcnt(0)
    v_mfma_f32_16x16x32_bf16 v[64:67], v[176:179], v[160:163], v[64:67]
    s_barrier
    ds_read_b128 v[144:147], v13 offset:32768
    v_mfma_f32_16x16x32_bf16 v[68:71], v[176:179], v[164:167], v[68:71]
    ds_read_b128 v[128:131], v11 offset:32768
    v_mfma_f32_16x16x32_bf16 v[72:75], v[176:179], v[168:171], v[72:75]
    ds_read_b128 v[148:151], v13 offset:34816
    v_mfma_f32_16x16x32_bf16 v[76:79], v[176:179], v[172:175], v[76:79]
    ds_read_b128 v[132:135], v11 offset:34816
    v_mfma_f32_16x16x32_bf16 v[80:83], v[180:183], v[160:163], v[80:83]
    ds_read_b128 v[152:155], v13 offset:36864
    v_mfma_f32_16x16x32_bf16 v[84:87], v[180:183], v[164:167], v[84:87]
    ds_read_b128 v[136:139], v11 offset:36864
    v_mfma_f32_16x16x32_bf16 v[88:91], v[180:183], v[168:171], v[88:91]
    ds_read_b128 v[156:159], v13 offset:38912
    v_mfma_f32_16x16x32_bf16 v[92:95], v[180:183], v[172:175], v[92:95]
    ds_read_b128 v[140:143], v11 offset:38912
    v_mfma_f32_16x16x32_bf16 v[96:99], v[184:187], v[160:163], v[96:99]
    v_mfma_f32_16x16x32_bf16 v[100:103], v[184:187], v[164:167], v[100:103]
    v_mfma_f32_16x16x32_bf16 v[104:107], v[184:187], v[168:171], v[104:107]
    v_mfma_f32_16x16x32_bf16 v[108:111], v[184:187], v[172:175], v[108:111]
    v_mfma_f32_16x16x32_bf16 v[112:115], v[188:191], v[160:163], v[112:115]
    v_mfma_f32_16x16x32_bf16 v[116:119], v[188:191], v[164:167], v[116:119]
    v_mfma_f32_16x16x32_bf16 v[120:123], v[188:191], v[168:171], v[120:123]
    v_mfma_f32_16x16x32_bf16 v[124:127], v[188:191], v[172:175], v[124:127]
    s_waitcnt lgkmcnt(0)
    v_mfma_f32_16x16x32_bf16 v[64:67], v[144:147], v[128:131], v[64:67]
    ds_read_b128 v[176:179], v13 offset:33792
    v_mfma_f32_16x16x32_bf16 v[68:71], v[144:147], v[132:135], v[68:71]
    ds_read_b128 v[160:163], v12 offset:32768
    v_mfma_f32_16x16x32_bf16 v[72:75], v[144:147], v[136:139], v[72:75]
    ds_read_b128 v[180:183], v13 offset:35840
    v_mfma_f32_16x16x32_bf16 v[76:79], v[144:147], v[140:143], v[76:79]
    ds_read_b128 v[164:167], v12 offset:34816
    v_mfma_f32_16x16x32_bf16 v[80:83], v[148:151], v[128:131], v[80:83]
    ds_read_b128 v[184:187], v13 offset:37888
    v_mfma_f32_16x16x32_bf16 v[84:87], v[148:151], v[132:135], v[84:87]
    ds_read_b128 v[168:171], v12 offset:36864
    v_mfma_f32_16x16x32_bf16 v[88:91], v[148:151], v[136:139], v[88:91]
    ds_read_b128 v[188:191], v13 offset:39936
    v_mfma_f32_16x16x32_bf16 v[92:95], v[148:151], v[140:143], v[92:95]
    ds_read_b128 v[172:175], v12 offset:38912
    v_mfma_f32_16x16x32_bf16 v[96:99], v[152:155], v[128:131], v[96:99]
    v_mfma_f32_16x16x32_bf16 v[100:103], v[152:155], v[132:135], v[100:103]
    v_mfma_f32_16x16x32_bf16 v[104:107], v[152:155], v[136:139], v[104:107]
    v_mfma_f32_16x16x32_bf16 v[108:111], v[152:155], v[140:143], v[108:111]
    v_mfma_f32_16x16x32_bf16 v[112:115], v[156:159], v[128:131], v[112:115]
    v_mfma_f32_16x16x32_bf16 v[116:119], v[156:159], v[132:135], v[116:119]
    v_mfma_f32_16x16x32_bf16 v[120:123], v[156:159], v[136:139], v[120:123]
    v_mfma_f32_16x16x32_bf16 v[124:127], v[156:159], v[140:143], v[124:127]
    s_waitcnt lgkmcnt(0)
    v_mfma_f32_16x16x32_bf16 v[64:67], v[176:179], v[160:163], v[64:67]
    s_barrier
    ds_read_b128 v[144:147], v16 offset:0
    v_mfma_f32_16x16x32_bf16 v[68:71], v[176:179], v[164:167], v[68:71]
    ds_read_b128 v[128:131], v14 offset:0
    v_mfma_f32_16x16x32_bf16 v[72:75], v[176:179], v[168:171], v[72:75]
    ds_read_b128 v[148:151], v16 offset:2048
    v_mfma_f32_16x16x32_bf16 v[76:79], v[176:179], v[172:175], v[76:79]
    ds_read_b128 v[132:135], v14 offset:2048
    v_mfma_f32_16x16x32_bf16 v[80:83], v[180:183], v[160:163], v[80:83]
    ds_read_b128 v[152:155], v16 offset:4096
    v_mfma_f32_16x16x32_bf16 v[84:87], v[180:183], v[164:167], v[84:87]
    ds_read_b128 v[136:139], v14 offset:4096
    v_mfma_f32_16x16x32_bf16 v[88:91], v[180:183], v[168:171], v[88:91]
    ds_read_b128 v[156:159], v16 offset:6144
    v_mfma_f32_16x16x32_bf16 v[92:95], v[180:183], v[172:175], v[92:95]
    ds_read_b128 v[140:143], v14 offset:6144
    v_mfma_f32_16x16x32_bf16 v[96:99], v[184:187], v[160:163], v[96:99]
    v_mfma_f32_16x16x32_bf16 v[100:103], v[184:187], v[164:167], v[100:103]
    v_mfma_f32_16x16x32_bf16 v[104:107], v[184:187], v[168:171], v[104:107]
    v_mfma_f32_16x16x32_bf16 v[108:111], v[184:187], v[172:175], v[108:111]
    v_mfma_f32_16x16x32_bf16 v[112:115], v[188:191], v[160:163], v[112:115]
    v_mfma_f32_16x16x32_bf16 v[116:119], v[188:191], v[164:167], v[116:119]
    v_mfma_f32_16x16x32_bf16 v[120:123], v[188:191], v[168:171], v[120:123]
    v_mfma_f32_16x16x32_bf16 v[124:127], v[188:191], v[172:175], v[124:127]
    s_waitcnt lgkmcnt(0)
    v_mfma_f32_16x16x32_bf16 v[64:67], v[144:147], v[128:131], v[64:67]
    ds_read_b128 v[176:179], v16 offset:1024
    v_mfma_f32_16x16x32_bf16 v[68:71], v[144:147], v[132:135], v[68:71]
    ds_read_b128 v[160:163], v15 offset:0
    v_mfma_f32_16x16x32_bf16 v[72:75], v[144:147], v[136:139], v[72:75]
    ds_read_b128 v[180:183], v16 offset:3072
    v_mfma_f32_16x16x32_bf16 v[76:79], v[144:147], v[140:143], v[76:79]
    ds_read_b128 v[164:167], v15 offset:2048
    v_mfma_f32_16x16x32_bf16 v[80:83], v[148:151], v[128:131], v[80:83]
    ds_read_b128 v[184:187], v16 offset:5120
    v_mfma_f32_16x16x32_bf16 v[84:87], v[148:151], v[132:135], v[84:87]
    ds_read_b128 v[168:171], v15 offset:4096
    v_mfma_f32_16x16x32_bf16 v[88:91], v[148:151], v[136:139], v[88:91]
    ds_read_b128 v[188:191], v16 offset:7168
    v_mfma_f32_16x16x32_bf16 v[92:95], v[148:151], v[140:143], v[92:95]
    ds_read_b128 v[172:175], v15 offset:6144
    v_mfma_f32_16x16x32_bf16 v[96:99], v[152:155], v[128:131], v[96:99]
    v_mfma_f32_16x16x32_bf16 v[100:103], v[152:155], v[132:135], v[100:103]
    v_mfma_f32_16x16x32_bf16 v[104:107], v[152:155], v[136:139], v[104:107]
    v_mfma_f32_16x16x32_bf16 v[108:111], v[152:155], v[140:143], v[108:111]
    v_mfma_f32_16x16x32_bf16 v[112:115], v[156:159], v[128:131], v[112:115]
    v_mfma_f32_16x16x32_bf16 v[116:119], v[156:159], v[132:135], v[116:119]
    v_mfma_f32_16x16x32_bf16 v[120:123], v[156:159], v[136:139], v[120:123]
    v_mfma_f32_16x16x32_bf16 v[124:127], v[156:159], v[140:143], v[124:127]
    s_waitcnt lgkmcnt(0)
    v_mfma_f32_16x16x32_bf16 v[64:67], v[176:179], v[160:163], v[64:67]
    s_barrier
    ds_read_b128 v[144:147], v10 offset:0
    v_mfma_f32_16x16x32_bf16 v[68:71], v[176:179], v[164:167], v[68:71]
    ds_read_b128 v[128:131], v8 offset:0
    v_mfma_f32_16x16x32_bf16 v[72:75], v[176:179], v[168:171], v[72:75]
    ds_read_b128 v[148:151], v10 offset:2048
    v_mfma_f32_16x16x32_bf16 v[76:79], v[176:179], v[172:175], v[76:79]
    ds_read_b128 v[132:135], v8 offset:2048
    v_mfma_f32_16x16x32_bf16 v[80:83], v[180:183], v[160:163], v[80:83]
    ds_read_b128 v[152:155], v10 offset:4096
    v_mfma_f32_16x16x32_bf16 v[84:87], v[180:183], v[164:167], v[84:87]
    ds_read_b128 v[136:139], v8 offset:4096
    v_mfma_f32_16x16x32_bf16 v[88:91], v[180:183], v[168:171], v[88:91]
    ds_read_b128 v[156:159], v10 offset:6144
    v_mfma_f32_16x16x32_bf16 v[92:95], v[180:183], v[172:175], v[92:95]
    ds_read_b128 v[140:143], v8 offset:6144
    v_mfma_f32_16x16x32_bf16 v[96:99], v[184:187], v[160:163], v[96:99]
    v_mfma_f32_16x16x32_bf16 v[100:103], v[184:187], v[164:167], v[100:103]
    v_mfma_f32_16x16x32_bf16 v[104:107], v[184:187], v[168:171], v[104:107]
    v_mfma_f32_16x16x32_bf16 v[108:111], v[184:187], v[172:175], v[108:111]
    v_mfma_f32_16x16x32_bf16 v[112:115], v[188:191], v[160:163], v[112:115]
    v_mfma_f32_16x16x32_bf16 v[116:119], v[188:191], v[164:167], v[116:119]
    v_mfma_f32_16x16x32_bf16 v[120:123], v[188:191], v[168:171], v[120:123]
    v_mfma_f32_16x16x32_bf16 v[124:127], v[188:191], v[172:175], v[124:127]
    s_waitcnt lgkmcnt(0)
    v_mfma_f32_16x16x32_bf16 v[64:67], v[144:147], v[128:131], v[64:67]
    ds_read_b128 v[176:179], v10 offset:1024
    v_mfma_f32_16x16x32_bf16 v[68:71], v[144:147], v[132:135], v[68:71]
    ds_read_b128 v[160:163], v9 offset:0
    v_mfma_f32_16x16x32_bf16 v[72:75], v[144:147], v[136:139], v[72:75]
    ds_read_b128 v[180:183], v10 offset:3072
    v_mfma_f32_16x16x32_bf16 v[76:79], v[144:147], v[140:143], v[76:79]
    ds_read_b128 v[164:167], v9 offset:2048
    v_mfma_f32_16x16x32_bf16 v[80:83], v[148:151], v[128:131], v[80:83]
    ds_read_b128 v[184:187], v10 offset:5120
    v_mfma_f32_16x16x32_bf16 v[84:87], v[148:151], v[132:135], v[84:87]
    ds_read_b128 v[168:171], v9 offset:4096
    v_mfma_f32_16x16x32_bf16 v[88:91], v[148:151], v[136:139], v[88:91]
    ds_read_b128 v[188:191], v10 offset:7168
    v_mfma_f32_16x16x32_bf16 v[92:95], v[148:151], v[140:143], v[92:95]
    ds_read_b128 v[172:175], v9 offset:6144
    v_mfma_f32_16x16x32_bf16 v[96:99], v[152:155], v[128:131], v[96:99]
    v_mfma_f32_16x16x32_bf16 v[100:103], v[152:155], v[132:135], v[100:103]
    v_mfma_f32_16x16x32_bf16 v[104:107], v[152:155], v[136:139], v[104:107]
    v_mfma_f32_16x16x32_bf16 v[108:111], v[152:155], v[140:143], v[108:111]
    v_mfma_f32_16x16x32_bf16 v[112:115], v[156:159], v[128:131], v[112:115]
    v_mfma_f32_16x16x32_bf16 v[116:119], v[156:159], v[132:135], v[116:119]
    v_mfma_f32_16x16x32_bf16 v[120:123], v[156:159], v[136:139], v[120:123]
    v_mfma_f32_16x16x32_bf16 v[124:127], v[156:159], v[140:143], v[124:127]
    s_waitcnt lgkmcnt(0)
    v_mfma_f32_16x16x32_bf16 v[64:67], v[176:179], v[160:163], v[64:67]
    s_barrier
    ds_read_b128 v[144:147], v10 offset:32768
    v_mfma_f32_16x16x32_bf16 v[68:71], v[176:179], v[164:167], v[68:71]
    ds_read_b128 v[128:131], v8 offset:32768
    v_mfma_f32_16x16x32_bf16 v[72:75], v[176:179], v[168:171], v[72:75]
    ds_read_b128 v[148:151], v10 offset:34816
    v_mfma_f32_16x16x32_bf16 v[76:79], v[176:179], v[172:175], v[76:79]
    ds_read_b128 v[132:135], v8 offset:34816
    v_mfma_f32_16x16x32_bf16 v[80:83], v[180:183], v[160:163], v[80:83]
    ds_read_b128 v[152:155], v10 offset:36864
    v_mfma_f32_16x16x32_bf16 v[84:87], v[180:183], v[164:167], v[84:87]
    ds_read_b128 v[136:139], v8 offset:36864
    v_mfma_f32_16x16x32_bf16 v[88:91], v[180:183], v[168:171], v[88:91]
    ds_read_b128 v[156:159], v10 offset:38912
    v_mfma_f32_16x16x32_bf16 v[92:95], v[180:183], v[172:175], v[92:95]
    ds_read_b128 v[140:143], v8 offset:38912
    v_mfma_f32_16x16x32_bf16 v[96:99], v[184:187], v[160:163], v[96:99]
    v_mfma_f32_16x16x32_bf16 v[100:103], v[184:187], v[164:167], v[100:103]
    v_mfma_f32_16x16x32_bf16 v[104:107], v[184:187], v[168:171], v[104:107]
    v_mfma_f32_16x16x32_bf16 v[108:111], v[184:187], v[172:175], v[108:111]
    v_mfma_f32_16x16x32_bf16 v[112:115], v[188:191], v[160:163], v[112:115]
    v_mfma_f32_16x16x32_bf16 v[116:119], v[188:191], v[164:167], v[116:119]
    v_mfma_f32_16x16x32_bf16 v[120:123], v[188:191], v[168:171], v[120:123]
    v_mfma_f32_16x16x32_bf16 v[124:127], v[188:191], v[172:175], v[124:127]
    s_waitcnt lgkmcnt(0)
    v_mfma_f32_16x16x32_bf16 v[64:67], v[144:147], v[128:131], v[64:67]
    ds_read_b128 v[176:179], v10 offset:33792
    v_mfma_f32_16x16x32_bf16 v[68:71], v[144:147], v[132:135], v[68:71]
    ds_read_b128 v[160:163], v9 offset:32768
    v_mfma_f32_16x16x32_bf16 v[72:75], v[144:147], v[136:139], v[72:75]
    ds_read_b128 v[180:183], v10 offset:35840
    v_mfma_f32_16x16x32_bf16 v[76:79], v[144:147], v[140:143], v[76:79]
    ds_read_b128 v[164:167], v9 offset:34816
    v_mfma_f32_16x16x32_bf16 v[80:83], v[148:151], v[128:131], v[80:83]
    ds_read_b128 v[184:187], v10 offset:37888
    v_mfma_f32_16x16x32_bf16 v[84:87], v[148:151], v[132:135], v[84:87]
    ds_read_b128 v[168:171], v9 offset:36864
    v_mfma_f32_16x16x32_bf16 v[88:91], v[148:151], v[136:139], v[88:91]
    ds_read_b128 v[188:191], v10 offset:39936
    v_mfma_f32_16x16x32_bf16 v[92:95], v[148:151], v[140:143], v[92:95]
    ds_read_b128 v[172:175], v9 offset:38912
    v_mfma_f32_16x16x32_bf16 v[96:99], v[152:155], v[128:131], v[96:99]
    v_mfma_f32_16x16x32_bf16 v[100:103], v[152:155], v[132:135], v[100:103]
    v_mfma_f32_16x16x32_bf16 v[104:107], v[152:155], v[136:139], v[104:107]
    v_mfma_f32_16x16x32_bf16 v[108:111], v[152:155], v[140:143], v[108:111]
    v_mfma_f32_16x16x32_bf16 v[112:115], v[156:159], v[128:131], v[112:115]
    v_mfma_f32_16x16x32_bf16 v[116:119], v[156:159], v[132:135], v[116:119]
    v_mfma_f32_16x16x32_bf16 v[120:123], v[156:159], v[136:139], v[120:123]
    v_mfma_f32_16x16x32_bf16 v[124:127], v[156:159], v[140:143], v[124:127]
    s_waitcnt lgkmcnt(0)
    v_mfma_f32_16x16x32_bf16 v[64:67], v[176:179], v[160:163], v[64:67]
    s_barrier
    ds_read_b128 v[144:147], v13 offset:0
    v_mfma_f32_16x16x32_bf16 v[68:71], v[176:179], v[164:167], v[68:71]
    ds_read_b128 v[128:131], v11 offset:0
    v_mfma_f32_16x16x32_bf16 v[72:75], v[176:179], v[168:171], v[72:75]
    ds_read_b128 v[148:151], v13 offset:2048
    v_mfma_f32_16x16x32_bf16 v[76:79], v[176:179], v[172:175], v[76:79]
    ds_read_b128 v[132:135], v11 offset:2048
    v_mfma_f32_16x16x32_bf16 v[80:83], v[180:183], v[160:163], v[80:83]
    ds_read_b128 v[152:155], v13 offset:4096
    v_mfma_f32_16x16x32_bf16 v[84:87], v[180:183], v[164:167], v[84:87]
    ds_read_b128 v[136:139], v11 offset:4096
    v_mfma_f32_16x16x32_bf16 v[88:91], v[180:183], v[168:171], v[88:91]
    ds_read_b128 v[156:159], v13 offset:6144
    v_mfma_f32_16x16x32_bf16 v[92:95], v[180:183], v[172:175], v[92:95]
    ds_read_b128 v[140:143], v11 offset:6144
    v_mfma_f32_16x16x32_bf16 v[96:99], v[184:187], v[160:163], v[96:99]
    v_mfma_f32_16x16x32_bf16 v[100:103], v[184:187], v[164:167], v[100:103]
    v_mfma_f32_16x16x32_bf16 v[104:107], v[184:187], v[168:171], v[104:107]
    v_mfma_f32_16x16x32_bf16 v[108:111], v[184:187], v[172:175], v[108:111]
    v_mfma_f32_16x16x32_bf16 v[112:115], v[188:191], v[160:163], v[112:115]
    v_mfma_f32_16x16x32_bf16 v[116:119], v[188:191], v[164:167], v[116:119]
    v_mfma_f32_16x16x32_bf16 v[120:123], v[188:191], v[168:171], v[120:123]
    v_mfma_f32_16x16x32_bf16 v[124:127], v[188:191], v[172:175], v[124:127]
    s_waitcnt lgkmcnt(0)
    v_mfma_f32_16x16x32_bf16 v[64:67], v[144:147], v[128:131], v[64:67]
    ds_read_b128 v[176:179], v13 offset:1024
    v_mfma_f32_16x16x32_bf16 v[68:71], v[144:147], v[132:135], v[68:71]
    ds_read_b128 v[160:163], v12 offset:0
    v_mfma_f32_16x16x32_bf16 v[72:75], v[144:147], v[136:139], v[72:75]
    ds_read_b128 v[180:183], v13 offset:3072
    v_mfma_f32_16x16x32_bf16 v[76:79], v[144:147], v[140:143], v[76:79]
    ds_read_b128 v[164:167], v12 offset:2048
    v_mfma_f32_16x16x32_bf16 v[80:83], v[148:151], v[128:131], v[80:83]
    ds_read_b128 v[184:187], v13 offset:5120
    v_mfma_f32_16x16x32_bf16 v[84:87], v[148:151], v[132:135], v[84:87]
    ds_read_b128 v[168:171], v12 offset:4096
    v_mfma_f32_16x16x32_bf16 v[88:91], v[148:151], v[136:139], v[88:91]
    ds_read_b128 v[188:191], v13 offset:7168
    v_mfma_f32_16x16x32_bf16 v[92:95], v[148:151], v[140:143], v[92:95]
    ds_read_b128 v[172:175], v12 offset:6144
    v_mfma_f32_16x16x32_bf16 v[96:99], v[152:155], v[128:131], v[96:99]
    v_mfma_f32_16x16x32_bf16 v[100:103], v[152:155], v[132:135], v[100:103]
    v_mfma_f32_16x16x32_bf16 v[104:107], v[152:155], v[136:139], v[104:107]
    v_mfma_f32_16x16x32_bf16 v[108:111], v[152:155], v[140:143], v[108:111]
    v_mfma_f32_16x16x32_bf16 v[112:115], v[156:159], v[128:131], v[112:115]
    v_mfma_f32_16x16x32_bf16 v[116:119], v[156:159], v[132:135], v[116:119]
    v_mfma_f32_16x16x32_bf16 v[120:123], v[156:159], v[136:139], v[120:123]
    v_mfma_f32_16x16x32_bf16 v[124:127], v[156:159], v[140:143], v[124:127]
    s_waitcnt lgkmcnt(0)
    v_mfma_f32_16x16x32_bf16 v[64:67], v[176:179], v[160:163], v[64:67]
    s_barrier
    ds_read_b128 v[144:147], v13 offset:32768
    v_mfma_f32_16x16x32_bf16 v[68:71], v[176:179], v[164:167], v[68:71]
    ds_read_b128 v[128:131], v11 offset:32768
    v_mfma_f32_16x16x32_bf16 v[72:75], v[176:179], v[168:171], v[72:75]
    ds_read_b128 v[148:151], v13 offset:34816
    v_mfma_f32_16x16x32_bf16 v[76:79], v[176:179], v[172:175], v[76:79]
    ds_read_b128 v[132:135], v11 offset:34816
    v_mfma_f32_16x16x32_bf16 v[80:83], v[180:183], v[160:163], v[80:83]
    ds_read_b128 v[152:155], v13 offset:36864
    v_mfma_f32_16x16x32_bf16 v[84:87], v[180:183], v[164:167], v[84:87]
    ds_read_b128 v[136:139], v11 offset:36864
    v_mfma_f32_16x16x32_bf16 v[88:91], v[180:183], v[168:171], v[88:91]
    ds_read_b128 v[156:159], v13 offset:38912
    v_mfma_f32_16x16x32_bf16 v[92:95], v[180:183], v[172:175], v[92:95]
    ds_read_b128 v[140:143], v11 offset:38912
    v_mfma_f32_16x16x32_bf16 v[96:99], v[184:187], v[160:163], v[96:99]
    v_mfma_f32_16x16x32_bf16 v[100:103], v[184:187], v[164:167], v[100:103]
    v_mfma_f32_16x16x32_bf16 v[104:107], v[184:187], v[168:171], v[104:107]
    v_mfma_f32_16x16x32_bf16 v[108:111], v[184:187], v[172:175], v[108:111]
    v_mfma_f32_16x16x32_bf16 v[112:115], v[188:191], v[160:163], v[112:115]
    v_mfma_f32_16x16x32_bf16 v[116:119], v[188:191], v[164:167], v[116:119]
    v_mfma_f32_16x16x32_bf16 v[120:123], v[188:191], v[168:171], v[120:123]
    v_mfma_f32_16x16x32_bf16 v[124:127], v[188:191], v[172:175], v[124:127]
    s_waitcnt lgkmcnt(0)
    v_mfma_f32_16x16x32_bf16 v[64:67], v[144:147], v[128:131], v[64:67]
    ds_read_b128 v[176:179], v13 offset:33792
    v_mfma_f32_16x16x32_bf16 v[68:71], v[144:147], v[132:135], v[68:71]
    ds_read_b128 v[160:163], v12 offset:32768
    v_mfma_f32_16x16x32_bf16 v[72:75], v[144:147], v[136:139], v[72:75]
    ds_read_b128 v[180:183], v13 offset:35840
    v_mfma_f32_16x16x32_bf16 v[76:79], v[144:147], v[140:143], v[76:79]
    ds_read_b128 v[164:167], v12 offset:34816
    v_mfma_f32_16x16x32_bf16 v[80:83], v[148:151], v[128:131], v[80:83]
    ds_read_b128 v[184:187], v13 offset:37888
    v_mfma_f32_16x16x32_bf16 v[84:87], v[148:151], v[132:135], v[84:87]
    ds_read_b128 v[168:171], v12 offset:36864
    v_mfma_f32_16x16x32_bf16 v[88:91], v[148:151], v[136:139], v[88:91]
    ds_read_b128 v[188:191], v13 offset:39936
    v_mfma_f32_16x16x32_bf16 v[92:95], v[148:151], v[140:143], v[92:95]
    ds_read_b128 v[172:175], v12 offset:38912
    v_mfma_f32_16x16x32_bf16 v[96:99], v[152:155], v[128:131], v[96:99]
    v_mfma_f32_16x16x32_bf16 v[100:103], v[152:155], v[132:135], v[100:103]
    v_mfma_f32_16x16x32_bf16 v[104:107], v[152:155], v[136:139], v[104:107]
    v_mfma_f32_16x16x32_bf16 v[108:111], v[152:155], v[140:143], v[108:111]
    v_mfma_f32_16x16x32_bf16 v[112:115], v[156:159], v[128:131], v[112:115]
    v_mfma_f32_16x16x32_bf16 v[116:119], v[156:159], v[132:135], v[116:119]
    v_mfma_f32_16x16x32_bf16 v[120:123], v[156:159], v[136:139], v[120:123]
    v_mfma_f32_16x16x32_bf16 v[124:127], v[156:159], v[140:143], v[124:127]
    s_waitcnt lgkmcnt(0)
    v_mfma_f32_16x16x32_bf16 v[64:67], v[176:179], v[160:163], v[64:67]
    v_mfma_f32_16x16x32_bf16 v[68:71], v[176:179], v[164:167], v[68:71]
    v_mfma_f32_16x16x32_bf16 v[72:75], v[176:179], v[168:171], v[72:75]
    v_mfma_f32_16x16x32_bf16 v[76:79], v[176:179], v[172:175], v[76:79]
    v_mfma_f32_16x16x32_bf16 v[80:83], v[180:183], v[160:163], v[80:83]
    v_mfma_f32_16x16x32_bf16 v[84:87], v[180:183], v[164:167], v[84:87]
    v_mfma_f32_16x16x32_bf16 v[88:91], v[180:183], v[168:171], v[88:91]
    v_mfma_f32_16x16x32_bf16 v[92:95], v[180:183], v[172:175], v[92:95]
    v_mfma_f32_16x16x32_bf16 v[96:99], v[184:187], v[160:163], v[96:99]
    v_mfma_f32_16x16x32_bf16 v[100:103], v[184:187], v[164:167], v[100:103]
    v_mfma_f32_16x16x32_bf16 v[104:107], v[184:187], v[168:171], v[104:107]
    v_mfma_f32_16x16x32_bf16 v[108:111], v[184:187], v[172:175], v[108:111]
    v_mfma_f32_16x16x32_bf16 v[112:115], v[188:191], v[160:163], v[112:115]
    v_mfma_f32_16x16x32_bf16 v[116:119], v[188:191], v[164:167], v[116:119]
    v_mfma_f32_16x16x32_bf16 v[120:123], v[188:191], v[168:171], v[120:123]
    v_mfma_f32_16x16x32_bf16 v[124:127], v[188:191], v[172:175], v[124:127]
    s_lshl_b32 s35, s30, 7
    s_lshl_b32 s36, s33, 6
    s_add_u32 s35, s35, s36
    s_lshl_b32 s35, s35, 10
    s_lshl_b32 s36, s31, 12
    s_add_u32 s35, s35, s36
    s_lshl_b32 s36, s34, 11
    s_add_u32 s35, s35, s36
    s_lshl_b32 s36, s29, 1
    s_add_u32 s36, s36, s27
    s_lshl_b32 s36, s36, 21
    s_add_u32 s35, s35, s36
    s_add_u32 s35, s35, 4194304
    v_lshlrev_b32 v7, 4, v6
    v_lshl_add_u32 v7, v4, 6, v7
    s_add_u32 s40, s35, 0
    s_add_u32 s41, s35, 16384
    s_add_u32 s42, s35, 32768
    s_add_u32 s43, s35, 49152
    v_cvt_pk_bf16_f32 v24, v64, v65
    v_cvt_pk_bf16_f32 v25, v66, v67
    v_cvt_pk_bf16_f32 v26, v80, v81
    v_cvt_pk_bf16_f32 v27, v82, v83
    buffer_store_dwordx4 v[24:27], v7, s[16:19], s40 offen offset:0 sc0 sc1
    v_cvt_pk_bf16_f32 v28, v96, v97
    v_cvt_pk_bf16_f32 v29, v98, v99
    v_cvt_pk_bf16_f32 v30, v112, v113
    v_cvt_pk_bf16_f32 v31, v114, v115
    buffer_store_dwordx4 v[28:31], v7, s[16:19], s40 offen offset:1024 sc0 sc1
    v_cvt_pk_bf16_f32 v32, v68, v69
    v_cvt_pk_bf16_f32 v33, v70, v71
    v_cvt_pk_bf16_f32 v34, v84, v85
    v_cvt_pk_bf16_f32 v35, v86, v87
    buffer_store_dwordx4 v[32:35], v7, s[16:19], s41 offen offset:0 sc0 sc1
    v_cvt_pk_bf16_f32 v36, v100, v101
    v_cvt_pk_bf16_f32 v37, v102, v103
    v_cvt_pk_bf16_f32 v38, v116, v117
    v_cvt_pk_bf16_f32 v39, v118, v119
    buffer_store_dwordx4 v[36:39], v7, s[16:19], s41 offen offset:1024 sc0 sc1
    v_cvt_pk_bf16_f32 v40, v72, v73
    v_cvt_pk_bf16_f32 v41, v74, v75
    v_cvt_pk_bf16_f32 v42, v88, v89
    v_cvt_pk_bf16_f32 v43, v90, v91
    buffer_store_dwordx4 v[40:43], v7, s[16:19], s42 offen offset:0 sc0 sc1
    v_cvt_pk_bf16_f32 v44, v104, v105
    v_cvt_pk_bf16_f32 v45, v106, v107
    v_cvt_pk_bf16_f32 v46, v120, v121
    v_cvt_pk_bf16_f32 v47, v122, v123
    buffer_store_dwordx4 v[44:47], v7, s[16:19], s42 offen offset:1024 sc0 sc1
    v_cvt_pk_bf16_f32 v48, v76, v77
    v_cvt_pk_bf16_f32 v49, v78, v79
    v_cvt_pk_bf16_f32 v50, v92, v93
    v_cvt_pk_bf16_f32 v51, v94, v95
    buffer_store_dwordx4 v[48:51], v7, s[16:19], s43 offen offset:0 sc0 sc1
    v_cvt_pk_bf16_f32 v52, v108, v109
    v_cvt_pk_bf16_f32 v53, v110, v111
    v_cvt_pk_bf16_f32 v54, v124, v125
    v_cvt_pk_bf16_f32 v55, v126, v127
    buffer_store_dwordx4 v[52:55], v7, s[16:19], s43 offen offset:1024 sc0 sc1
    s_waitcnt vmcnt(0)
k1_kernelg_fin:
    s_and_b32 s3, s2, 7
    s_and_b32 s29, s3, 1
    s_bfe_u32 s27, s3, 0x10001
    s_lshl_b32 s62, s29, 1
    s_add_u32 s62, s62, s27
    s_lshl_b32 s62, s62, 2
    s_add_u32 s62, s62, s31
    s_lshl_b32 s63, s30, 4
    s_add_u32 s63, s63, s62
    s_lshl_b32 s46, s63, 7
    s_add_u32 s46, s46, 16252928
    s_barrier
    s_cmp_lg_u32 s32, 0
    s_cbranch_scc1 k1_kernelg_nf
    v_mov_b32 v198, 0
    buffer_store_dword v199, v198, s[16:19], s46 offen sc0 sc1
k1_kernelg_nf:
    s_barrier
    s_load_dwordx2 s[10:11], s[0:1], 96
    s_load_dwordx2 s[4:5], s[0:1], 0
    s_load_dwordx2 s[6:7], s[0:1], 48
    s_load_dwordx2 s[8:9], s[0:1], 80
    s_load_dwordx4 s[56:59], s[0:1], 56
    s_load_dwordx2 s[60:61], s[0:1], 72
    v_mbcnt_lo_u32_b32 v2, -1, 0
    v_mbcnt_hi_u32_b32 v2, -1, v2
    s_lshl_b32 s33, s32, 6
    v_add_u32 v0, s33, v2
    v_lshlrev_b32 v3, 4, v2
    s_lshl_b32 s33, s63, 3
    s_add_u32 s33, s33, s32
    s_lshl_b32 s34, s33, 10
    s_lshr_b32 s47, s33, 4
    s_lshl_b32 s47, s47, 14
    s_and_b32 s46, s33, 15
    s_lshl_b32 s46, s46, 6
    s_add_u32 s47, s47, s46
    v_lshrrev_b32 v90, 2, v2
    v_lshlrev_b32 v90, 10, v90
    v_and_b32 v91, 3, v2
    v_lshl_add_u32 v90, v91, 4, v90
    s_add_u32 s35, s47, 4194304
    s_add_u32 s36, s47, 8388608
    s_add_u32 s43, s47, 6291456
    s_add_u32 s44, s47, 10485760
    s_mov_b32 s53, 0xffff0000
    s_mov_b32 s69, 0x40000
    s_mov_b32 s45, 13631488
    v_mov_b32 v5, 0
    v_lshrrev_b32 v6, 2, v0
    s_mov_b32 s46, 14336
    v_mul_lo_u32 v7, v6, s46
    v_and_b32 v4, 3, v0
    v_lshl_add_u32 v7, v4, 4, v7
    v_lshlrev_b32 v4, 5, v2
    s_waitcnt lgkmcnt(0)
    s_mov_b32 s24, s10
    s_and_b32 s25, s11, 0xffff
    s_mov_b32 s26, 16777216
    s_mov_b32 s27, 0x00020000
    s_mov_b32 s20, s8
    s_and_b32 s21, s9, 0xffff
    s_mov_b32 s22, 2097152
    s_mov_b32 s23, 0x00020000
    buffer_load_dword v88, v5, s[24:27], s45 offen
    s_mov_b32 s12, s4
    s_and_b32 s13, s5, 0xffff
    s_mov_b32 s14, 2097152
    s_mov_b32 s15, 0x00020000
    buffer_load_dwordx4 v[24:27], v3, s[12:15], s34 offen
    s_mov_b32 s16, s6
    s_and_b32 s17, s7, 0xffff
    s_mov_b32 s18, 1024
    s_mov_b32 s19, 0x00020000
    buffer_load_dwordx4 v[8:11], v3, s[16:19], 0 offen
    s_cmp_lg_u32 s32, 4
    s_cbranch_scc1 k1_kernelgt_np
    s_lshr_b32 s46, s63, 4
    s_lshl_b32 s46, s46, 11
    s_add_u32 s46, s46, 16252928
    v_and_b32 v56, 15, v2
    v_lshlrev_b32 v56, 7, v56
k1_kernelgt_fp:
    buffer_load_dword v57, v56, s[24:27], s46 offen sc1
    s_waitcnt vmcnt(0)
    v_cmp_ne_u32 vcc, v57, v88
    s_or_b32 s47, vcc_lo, vcc_hi
    s_cbranch_scc0 k1_kernelgt_np
    s_sleep 1
    s_sub_u32 s69, s69, 1
    s_cbranch_scc0 k1_kernelgt_fp
    s_mov_b32 s69, 0
k1_kernelgt_np:
    s_barrier
    buffer_load_dwordx4 v[16:19], v90, s[24:27], s35 offen sc1
    buffer_load_dwordx4 v[28:31], v90, s[24:27], s43 offen sc1
    buffer_load_dwordx4 v[20:23], v90, s[24:27], s36 offen sc1
    buffer_load_dwordx4 v[12:15], v90, s[24:27], s44 offen sc1
    s_waitcnt vmcnt(0)
    v_lshlrev_b32 v56, 16, v16
    v_lshlrev_b32 v66, 16, v17
    v_and_b32 v57, s53, v16
    v_and_b32 v67, s53, v17
    v_lshlrev_b32 v58, 16, v28
    v_lshlrev_b32 v68, 16, v29
    v_and_b32 v59, s53, v28
    v_and_b32 v69, s53, v29
    v_lshlrev_b32 v60, 16, v20
    v_lshlrev_b32 v70, 16, v21
    v_and_b32 v61, s53, v20
    v_and_b32 v71, s53, v21
    v_lshlrev_b32 v62, 16, v12
    v_lshlrev_b32 v72, 16, v13
    v_and_b32 v63, s53, v12
    v_and_b32 v73, s53, v13
    v_add_f32 v56, v56, v58
    v_add_f32 v66, v66, v68
    v_add_f32 v57, v57, v59
    v_add_f32 v67, v67, v69
    v_add_f32 v60, v60, v62
    v_add_f32 v70, v70, v72
    v_add_f32 v61, v61, v63
    v_add_f32 v71, v71, v73
    v_cvt_pk_bf16_f32 v64, v56, v57
    v_cvt_pk_bf16_f32 v74, v66, v67
    v_cvt_pk_bf16_f32 v65, v60, v61
    v_cvt_pk_bf16_f32 v75, v70, v71
    v_lshlrev_b32 v56, 16, v64
    v_lshlrev_b32 v66, 16, v74
    v_and_b32 v57, s53, v64
    v_and_b32 v67, s53, v74
    v_lshlrev_b32 v58, 16, v65
    v_lshlrev_b32 v68, 16, v75
    v_and_b32 v59, s53, v65
    v_and_b32 v69, s53, v75
    v_sub_f32 v56, v56, v58
    v_sub_f32 v66, v66, v68
    v_sub_f32 v57, v57, v59
    v_sub_f32 v67, v67, v69
    v_cvt_pk_bf16_f32 v60, v56, v57
    v_cvt_pk_bf16_f32 v70, v66, v67
    v_lshlrev_b32 v56, 16, v60
    v_lshlrev_b32 v66, 16, v70
    v_and_b32 v57, s53, v60
    v_and_b32 v67, s53, v70
    v_lshlrev_b32 v58, 16, v24
    v_lshlrev_b32 v68, 16, v25
    v_and_b32 v59, s53, v24
    v_and_b32 v69, s53, v25
    v_add_f32 v56, v58, v56
    v_add_f32 v66, v68, v66
    v_add_f32 v57, v59, v57
    v_add_f32 v67, v69, v67
    v_cvt_pk_bf16_f32 v40, v56, v57
    v_cvt_pk_bf16_f32 v41, v66, v67
    v_lshlrev_b32 v32, 16, v40
    v_lshlrev_b32 v34, 16, v41
    v_and_b32 v33, s53, v40
    v_and_b32 v35, s53, v41
    v_lshlrev_b32 v56, 16, v18
    v_lshlrev_b32 v66, 16, v19
    v_and_b32 v57, s53, v18
    v_and_b32 v67, s53, v19
    v_lshlrev_b32 v58, 16, v30
    v_lshlrev_b32 v68, 16, v31
    v_and_b32 v59, s53, v30
    v_and_b32 v69, s53, v31
    v_lshlrev_b32 v60, 16, v22
    v_lshlrev_b32 v70, 16, v23
    v_and_b32 v61, s53, v22
    v_and_b32 v71, s53, v23
    v_lshlrev_b32 v62, 16, v14
    v_lshlrev_b32 v72, 16, v15
    v_and_b32 v63, s53, v14
    v_and_b32 v73, s53, v15
    v_add_f32 v56, v56, v58
    v_add_f32 v66, v66, v68
    v_add_f32 v57, v57, v59
    v_add_f32 v67, v67, v69
    v_add_f32 v60, v60, v62
    v_add_f32 v70, v70, v72
    v_add_f32 v61, v61, v63
    v_add_f32 v71, v71, v73
    v_cvt_pk_bf16_f32 v64, v56, v57
    v_cvt_pk_bf16_f32 v74, v66, v67
    v_cvt_pk_bf16_f32 v65, v60, v61
    v_cvt_pk_bf16_f32 v75, v70, v71
    v_lshlrev_b32 v56, 16, v64
    v_lshlrev_b32 v66, 16, v74
    v_and_b32 v57, s53, v64
    v_and_b32 v67, s53, v74
    v_lshlrev_b32 v58, 16, v65
    v_lshlrev_b32 v68, 16, v75
    v_and_b32 v59, s53, v65
    v_and_b32 v69, s53, v75
    v_sub_f32 v56, v56, v58
    v_sub_f32 v66, v66, v68
    v_sub_f32 v57, v57, v59
    v_sub_f32 v67, v67, v69
    v_cvt_pk_bf16_f32 v60, v56, v57
    v_cvt_pk_bf16_f32 v70, v66, v67
    v_lshlrev_b32 v56, 16, v60
    v_lshlrev_b32 v66, 16, v70
    v_and_b32 v57, s53, v60
    v_and_b32 v67, s53, v70
    v_lshlrev_b32 v58, 16, v26
    v_lshlrev_b32 v68, 16, v27
    v_and_b32 v59, s53, v26
    v_and_b32 v69, s53, v27
    v_add_f32 v56, v58, v56
    v_add_f32 v66, v68, v66
    v_add_f32 v57, v59, v57
    v_add_f32 v67, v69, v67
    v_cvt_pk_bf16_f32 v42, v56, v57
    v_cvt_pk_bf16_f32 v43, v66, v67
    v_lshlrev_b32 v36, 16, v42
    v_lshlrev_b32 v38, 16, v43
    v_and_b32 v37, s53, v42
    v_and_b32 v39, s53, v43
    v_add_f32 v48, v32, v33
    v_add_f32 v49, v34, v35
    v_add_f32 v50, v36, v37
    v_add_f32 v51, v38, v39
    v_add_f32 v48, v48, v49
    v_add_f32 v50, v50, v51
    v_add_f32 v48, v48, v50
    s_nop 1
    v_add_f32_dpp v48, v48, v48 quad_perm:[1,0,3,2] row_mask:0xf bank_mask:0xf
    s_nop 1
    v_add_f32_dpp v48, v48, v48 quad_perm:[2,3,0,1] row_mask:0xf bank_mask:0xf
    s_nop 1
    v_add_f32_dpp v48, v48, v48 row_half_mirror row_mask:0xf bank_mask:0xf
    s_nop 1
    v_add_f32_dpp v48, v48, v48 row_mirror row_mask:0xf bank_mask:0xf
    v_mov_b32 v49, v48
    s_nop 1
    v_permlane16_swap_b32 v48, v49
    s_nop 1
    v_add_f32 v48, v48, v49
    v_mov_b32 v49, v48
    s_nop 1
    v_permlane32_swap_b32 v48, v49
    s_nop 1
    v_add_f32 v48, v48, v49
    v_mul_f32 v48, 0x3b000000, v48
    v_sub_f32 v56, v32, v48
    v_sub_f32 v57, v33, v48
    v_sub_f32 v58, v34, v48
    v_sub_f32 v59, v35, v48
    v_sub_f32 v60, v36, v48
    v_sub_f32 v61, v37, v48
    v_sub_f32 v62, v38, v48
    v_sub_f32 v63, v39, v48
    v_cvt_pk_bf16_f32 v49, v48, v48
    v_mul_f32 v50, v56, v56
    v_mul_f32 v51, v57, v57
    v_lshlrev_b32 v49, 16, v49
    v_fmac_f32 v50, v58, v58
    v_fmac_f32 v51, v59, v59
    v_fmac_f32 v50, v60, v60
    v_fmac_f32 v51, v61, v61
    v_fmac_f32 v50, v62, v62
    v_fmac_f32 v51, v63, v63
    v_add_f32 v50, v50, v51
    v_sub_f32 v66, v32, v49
    v_sub_f32 v67, v33, v49
    v_sub_f32 v68, v34, v49
    v_sub_f32 v69, v35, v49
    v_sub_f32 v70, v36, v49
    v_sub_f32 v71, v37, v49
    v_sub_f32 v72, v38, v49
    v_sub_f32 v73, v39, v49
    v_cvt_pk_bf16_f32 v76, v66, v67
    v_cvt_pk_bf16_f32 v77, v68, v69
    v_cvt_pk_bf16_f32 v78, v70, v71
    v_cvt_pk_bf16_f32 v79, v72, v73
    v_lshlrev_b32 v66, 16, v76
    v_and_b32 v67, s53, v76
    v_lshlrev_b32 v68, 16, v77
    v_and_b32 v69, s53, v77
    v_lshlrev_b32 v70, 16, v78
    v_and_b32 v71, s53, v78
    v_lshlrev_b32 v72, 16, v79
    v_and_b32 v73, s53, v79
    s_nop 1
    v_add_f32_dpp v50, v50, v50 quad_perm:[1,0,3,2] row_mask:0xf bank_mask:0xf
    s_nop 1
    v_add_f32_dpp v50, v50, v50 quad_perm:[2,3,0,1] row_mask:0xf bank_mask:0xf
    s_nop 1
    v_add_f32_dpp v50, v50, v50 row_half_mirror row_mask:0xf bank_mask:0xf
    s_nop 1
    v_add_f32_dpp v50, v50, v50 row_mirror row_mask:0xf bank_mask:0xf
    v_mov_b32 v51, v50
    s_nop 1
    v_permlane16_swap_b32 v50, v51
    s_nop 1
    v_add_f32 v50, v50, v51
    v_mov_b32 v51, v50
    s_nop 1
    v_permlane32_swap_b32 v50, v51
    s_nop 1
    v_add_f32 v50, v50, v51
    v_mul_f32 v50, 0x3b000000, v50
    v_cvt_pk_bf16_f32 v50, v50, v50
    v_lshlrev_b32 v50, 16, v50
    v_add_f32 v50, 0x3727c5ac, v50
    v_cvt_pk_bf16_f32 v50, v50, v50
    v_lshlrev_b32 v50, 16, v50
    v_sqrt_f32 v50, v50
    s_nop 0
    v_cvt_pk_bf16_f32 v50, v50, v50
    v_lshlrev_b32 v50, 16, v50
    v_rcp_f32 v50, v50
    s_waitcnt vmcnt(0)
    v_mul_f32 v66, v66, v50
    v_mul_f32 v67, v67, v50
    v_mul_f32 v68, v68, v50
    v_mul_f32 v69, v69, v50
    v_mul_f32 v70, v70, v50
    v_mul_f32 v71, v71, v50
    v_mul_f32 v72, v72, v50
    v_mul_f32 v73, v73, v50
    v_cvt_pk_bf16_f32 v44, v66, v67
    v_cvt_pk_bf16_f32 v45, v68, v69
    v_cvt_pk_bf16_f32 v46, v70, v71
    v_cvt_pk_bf16_f32 v47, v72, v73
    v_lshlrev_b32 v66, 16, v44
    v_and_b32 v67, s53, v44
    v_lshlrev_b32 v56, 16, v8
    v_and_b32 v57, s53, v8
    v_lshlrev_b32 v68, 16, v45
    v_and_b32 v69, s53, v45
    v_lshlrev_b32 v58, 16, v9
    v_and_b32 v59, s53, v9
    v_lshlrev_b32 v70, 16, v46
    v_and_b32 v71, s53, v46
    v_lshlrev_b32 v60, 16, v10
    v_and_b32 v61, s53, v10
    v_lshlrev_b32 v72, 16, v47
    v_and_b32 v73, s53, v47
    v_lshlrev_b32 v62, 16, v11
    v_and_b32 v63, s53, v11
    v_mul_f32 v52, v66, v56
    v_mul_f32 v53, v67, v57
    v_fmac_f32 v52, v68, v58
    v_fmac_f32 v53, v69, v59
    v_fmac_f32 v52, v70, v60
    v_fmac_f32 v53, v71, v61
    v_fmac_f32 v52, v72, v62
    v_fmac_f32 v53, v73, v63
    v_add_f32 v52, v52, v53
    s_nop 1
    v_add_f32_dpp v52, v52, v52 quad_perm:[1,0,3,2] row_mask:0xf bank_mask:0xf
    s_nop 1
    v_add_f32_dpp v52, v52, v52 quad_perm:[2,3,0,1] row_mask:0xf bank_mask:0xf
    s_nop 1
    v_add_f32_dpp v52, v52, v52 row_half_mirror row_mask:0xf bank_mask:0xf
    s_nop 1
    v_add_f32_dpp v52, v52, v52 row_mirror row_mask:0xf bank_mask:0xf
    v_mov_b32 v53, v52
    s_nop 1
    v_permlane16_swap_b32 v52, v53
    s_nop 1
    v_add_f32 v52, v52, v53
    v_mov_b32 v53, v52
    s_nop 1
    v_permlane32_swap_b32 v52, v53
    s_nop 1
    v_add_f32 v52, v52, v53
    v_cvt_pk_bf16_f32 v52, v52, v52
    v_lshlrev_b32 v52, 16, v52
    v_ashrrev_i32 v53, 31, v52
    v_or_b32 v53, 0x80000000, v53
    v_xor_b32 v52, v52, v53
    v_and_b32 v52, s53, v52
    s_sub_u32 s37, 2047, s33
    v_or_b32 v52, s37, v52
    s_lshl_b32 s37, s32, 2
    v_mov_b32 v89, s37
    ds_write_b32 v89, v52
    v_add_f32 v76, v32, v66
    v_add_f32 v77, v33, v67
    v_add_f32 v78, v34, v68
    v_add_f32 v79, v35, v69
    v_add_f32 v80, v36, v70
    v_add_f32 v81, v37, v71
    v_add_f32 v82, v38, v72
    v_add_f32 v83, v39, v73
    v_cvt_pk_bf16_f32 v84, v76, v77
    v_cvt_pk_bf16_f32 v85, v78, v79
    v_cvt_pk_bf16_f32 v86, v80, v81
    v_cvt_pk_bf16_f32 v87, v82, v83
    v_mov_b32 v56, v40
    v_mov_b32 v57, v88
    v_mov_b32 v64, v44
    v_mov_b32 v65, v88
    v_mov_b32 v58, v41
    v_mov_b32 v59, v88
    v_mov_b32 v66, v45
    v_mov_b32 v67, v88
    v_mov_b32 v60, v42
    v_mov_b32 v61, v88
    v_mov_b32 v68, v46
    v_mov_b32 v69, v88
    v_mov_b32 v62, v43
    v_mov_b32 v63, v88
    v_mov_b32 v70, v47
    v_mov_b32 v71, v88
    v_readfirstlane_b32 s39, v52
    v_readfirstlane_b32 s50, v88
    s_lshl_b32 s41, s63, 12
    s_add_u32 s41, s41, 13639680
    s_and_b32 s42, s63, 63
    s_lshl_b32 s42, s42, 7
    s_lshr_b32 s47, s63, 6
    s_lshl_b32 s47, s47, 3
    s_add_u32 s42, s42, s47
    s_add_u32 s42, s42, 16515072
    s_waitcnt lgkmcnt(0)
    s_barrier
    ds_read_b128 v[72:75], v5
    ds_read_b128 v[76:79], v5 offset:16
    s_waitcnt lgkmcnt(0)
    v_max3_u32 v72, v72, v73, v74
    v_max3_u32 v76, v76, v77, v78
    v_max3_u32 v72, v72, v75, v79
    v_max_u32 v72, v72, v76
    v_mov_b32 v73, v88
    s_nop 0
    v_readfirstlane_b32 s38, v72
    s_mov_b32 s51, 0
    s_cmp_lg_u32 s38, s39
    s_cbranch_scc1 k1_kernelgt_nc
    s_mov_b32 s51, 1
    buffer_store_dwordx2 v[72:73], v5, s[24:27], s42 offen sc0 sc1
    buffer_store_dwordx4 v[64:67], v4, s[24:27], s41 offen offset:2048 sc0 sc1
    buffer_store_dwordx4 v[68:71], v4, s[24:27], s41 offen offset:2064 sc0 sc1
    buffer_store_dwordx4 v[56:59], v4, s[24:27], s41 offen sc0 sc1
    buffer_store_dwordx4 v[60:63], v4, s[24:27], s41 offen offset:16 sc0 sc1
    s_branch k1_kernelgt_role
k1_kernelgt_nc:
    buffer_store_dwordx4 v[84:87], v3, s[20:23], s34 offen
k1_kernelgt_role:
    s_cmp_lt_u32 s2, 56
    s_cbranch_scc1 k1_kernelgt_needkeys
    s_sub_u32 s52, s2, 64
    s_cmp_lt_u32 s52, 16
    s_cbranch_scc1 k1_kernelgt_needkeys
    s_cmp_eq_u32 s51, 0
    s_cbranch_scc1 k1_kernelgt_fin
    s_mov_b32 s45, 13631616
k1_kernelgt_annp:
    s_sleep 8
    buffer_load_dwordx2 v[72:73], v5, s[24:27], s45 offen sc1
    s_waitcnt vmcnt(0)
    v_readfirstlane_b32 s46, v73
    v_readfirstlane_b32 s38, v72
    s_cmp_eq_u32 s46, s50
    s_cbranch_scc1 k1_kernelgt_annd
    s_sub_u32 s69, s69, 1
    s_cbranch_scc0 k1_kernelgt_annp
    s_mov_b32 s69, 0
k1_kernelgt_annd:
    s_cmp_eq_u32 s38, s39
    s_cbranch_scc1 k1_kernelgt_fin
    buffer_store_dwordx4 v[84:87], v3, s[20:23], s34 offen
    s_branch k1_kernelgt_fin
k1_kernelgt_needkeys:
    s_cmp_lt_u32 s2, 56
    s_cbranch_scc0 k1_kernelgt_nowd
    s_barrier
    s_mov_b32 s12, s56
    s_and_b32 s13, s57, 0xffff
    s_mov_b32 s14, 1835008
    s_mov_b32 s15, 0x00020000
    s_mov_b32 s16, s58
    s_and_b32 s17, s59, 0xffff
    s_mov_b32 s18, 1835008
    s_mov_b32 s19, 0x00020000
    s_lshl_b32 s48, s2, 6
    s_add_u32 s49, s48, 0
    buffer_load_dwordx4 v[96:99], v7, s[12:15], s49 offen
    buffer_load_dwordx4 v[112:115], v7, s[16:19], s49 offen
    s_add_u32 s49, s48, 3584
    buffer_load_dwordx4 v[100:103], v7, s[12:15], s49 offen
    buffer_load_dwordx4 v[116:119], v7, s[16:19], s49 offen
    s_add_u32 s49, s48, 7168
    buffer_load_dwordx4 v[104:107], v7, s[12:15], s49 offen
    buffer_load_dwordx4 v[120:123], v7, s[16:19], s49 offen
    s_add_u32 s49, s48, 10752
    buffer_load_dwordx4 v[108:111], v7, s[12:15], s49 offen
    buffer_load_dwordx4 v[124:127], v7, s[16:19], s49 offen
    s_mov_b32 s28, s60
    s_and_b32 s29, s61, 0xffff
    s_mov_b32 s30, 1835008
    s_mov_b32 s31, 0x00020000
    s_lshl_b32 s48, s2, 5
    s_lshl_b32 s49, s32, 2
    s_add_u32 s48, s48, s49
    s_lshl_b32 s48, s48, 10
    buffer_load_dwordx4 v[16:19], v3, s[28:31], s48 offen offset:0
    buffer_load_dwordx4 v[20:23], v3, s[28:31], s48 offen offset:1024
    buffer_load_dwordx4 v[24:27], v3, s[28:31], s48 offen offset:2048
    buffer_load_dwordx4 v[28:31], v3, s[28:31], s48 offen offset:3072
k1_kernelgt_nowd:
    s_cmp_lg_u32 s32, 0
    s_cbranch_scc1 k1_kernelgt_kw
    s_mov_b32 s45, 16515072
    v_lshlrev_b32 v64, 7, v2
k1_kernelgt_kp:
    buffer_load_dwordx4 v[56:59], v64, s[24:27], s45 offen sc1
    buffer_load_dwordx4 v[60:63], v64, s[24:27], s45 offen offset:16 sc1
    s_waitcnt vmcnt(0)
    v_cmp_ne_u32 s[46:47], v57, v88
    v_cmp_ne_u32 vcc, v59, v88
    s_or_b64 s[46:47], s[46:47], vcc
    v_cmp_ne_u32 vcc, v61, v88
    s_or_b64 s[46:47], s[46:47], vcc
    v_cmp_ne_u32 vcc, v63, v88
    s_or_b64 s[46:47], s[46:47], vcc
    s_cbranch_scc0 k1_kernelgt_kd
    s_sleep 1
    s_sub_u32 s69, s69, 1
    s_cbranch_scc0 k1_kernelgt_kp
    s_mov_b32 s69, 0
k1_kernelgt_kd:
    v_max3_u32 v56, v56, v58, v60
    v_max_u32 v56, v56, v62
    s_nop 1
    v_max_u32_dpp v56, v56, v56 quad_perm:[1,0,3,2] row_mask:0xf bank_mask:0xf
    s_nop 1
    v_max_u32_dpp v56, v56, v56 quad_perm:[2,3,0,1] row_mask:0xf bank_mask:0xf
    s_nop 1
    v_max_u32_dpp v56, v56, v56 row_half_mirror row_mask:0xf bank_mask:0xf
    s_nop 1
    v_max_u32_dpp v56, v56, v56 row_mirror row_mask:0xf bank_mask:0xf
    v_mov_b32 v57, v56
    s_nop 1
    v_permlane16_swap_b32 v56, v57
    s_nop 1
    v_max_u32 v56, v56, v57
    v_mov_b32 v57, v56
    s_nop 1
    v_permlane32_swap_b32 v56, v57
    s_nop 1
    v_max_u32 v56, v56, v57
    ds_write_b32 v5, v56 offset:64
    s_cmp_lg_u32 s2, 64
    s_cbranch_scc1 k1_kernelgt_noann
    v_mov_b32 v57, v88
    s_mov_b32 s45, 13631616
    buffer_store_dwordx2 v[56:57], v5, s[24:27], s45 offen sc0 sc1
k1_kernelgt_noann:
    s_waitcnt lgkmcnt(0)
k1_kernelgt_kw:
    s_barrier
    ds_read_b32 v56, v5 offset:64
    s_waitcnt lgkmcnt(0)
    v_readfirstlane_b32 s38, v56
    s_cmp_eq_u32 s51, 0
    s_cbranch_scc1 k1_kernelgt_nodef
    s_cmp_eq_u32 s38, s39
    s_cbranch_scc1 k1_kernelgt_nodef
    buffer_store_dwordx4 v[84:87], v3, s[20:23], s34 offen
k1_kernelgt_nodef:
    s_and_b32 s39, s38, 0xffff
    s_sub_u32 s39, 2047, s39
    s_lshr_b32 s40, s39, 3
    s_lshl_b32 s40, s40, 12
    s_add_u32 s40, s40, 13639680
    s_cmp_lt_u32 s2, 56
    s_cbranch_scc0 k1_kernelgt_red
    v_lshlrev_b32 v9, 4, v6
    v_add_u32 v9, s40, v9
k1_kernelgt_xp:
    buffer_load_dwordx4 v[56:59], v9, s[24:27], 0 offen offset:2048 sc1
    v_mov_b32 v32, 0
    v_mov_b32 v33, 0
    v_mov_b32 v34, 0
    v_mov_b32 v35, 0
    v_mov_b32 v36, 0
    v_mov_b32 v37, 0
    v_mov_b32 v38, 0
    v_mov_b32 v39, 0
    v_mov_b32 v40, 0
    v_mov_b32 v41, 0
    v_mov_b32 v42, 0
    v_mov_b32 v43, 0
    v_mov_b32 v44, 0
    v_mov_b32 v45, 0
    v_mov_b32 v46, 0
    v_mov_b32 v47, 0
    s_waitcnt vmcnt(0)
    v_cmp_ne_u32 s[46:47], v57, v88
    v_cmp_ne_u32 vcc, v59, v88
    s_or_b64 s[46:47], s[46:47], vcc
    s_cbranch_scc0 k1_kernelgt_xd
    s_sub_u32 s69, s69, 1
    s_cbranch_scc0 k1_kernelgt_xp
    s_mov_b32 s69, 0
k1_kernelgt_xd:
    v_lshlrev_b32 v60, 16, v56
    v_and_b32 v61, s53, v56
    v_lshlrev_b32 v62, 16, v58
    v_and_b32 v63, s53, v58
    v_lshlrev_b32 v64, 16, v96
    v_and_b32 v65, s53, v96
    v_lshlrev_b32 v66, 16, v97
    v_and_b32 v67, s53, v97
    v_lshlrev_b32 v68, 16, v98
    v_and_b32 v69, s53, v98
    v_lshlrev_b32 v70, 16, v99
    v_and_b32 v71, s53, v99
    v_fmac_f32 v32, v60, v64
    v_fmac_f32 v33, v60, v65
    v_fmac_f32 v34, v60, v66
    v_fmac_f32 v35, v60, v67
    v_fmac_f32 v36, v60, v68
    v_fmac_f32 v37, v60, v69
    v_fmac_f32 v38, v60, v70
    v_fmac_f32 v39, v60, v71
    v_lshlrev_b32 v64, 16, v112
    v_and_b32 v65, s53, v112
    v_lshlrev_b32 v66, 16, v113
    v_and_b32 v67, s53, v113
    v_lshlrev_b32 v68, 16, v114
    v_and_b32 v69, s53, v114
    v_lshlrev_b32 v70, 16, v115
    v_and_b32 v71, s53, v115
    v_fmac_f32 v40, v60, v64
    v_fmac_f32 v41, v60, v65
    v_fmac_f32 v42, v60, v66
    v_fmac_f32 v43, v60, v67
    v_fmac_f32 v44, v60, v68
    v_fmac_f32 v45, v60, v69
    v_fmac_f32 v46, v60, v70
    v_fmac_f32 v47, v60, v71
    v_lshlrev_b32 v64, 16, v100
    v_and_b32 v65, s53, v100
    v_lshlrev_b32 v66, 16, v101
    v_and_b32 v67, s53, v101
    v_lshlrev_b32 v68, 16, v102
    v_and_b32 v69, s53, v102
    v_lshlrev_b32 v70, 16, v103
    v_and_b32 v71, s53, v103
    v_fmac_f32 v32, v61, v64
    v_fmac_f32 v33, v61, v65
    v_fmac_f32 v34, v61, v66
    v_fmac_f32 v35, v61, v67
    v_fmac_f32 v36, v61, v68
    v_fmac_f32 v37, v61, v69
    v_fmac_f32 v38, v61, v70
    v_fmac_f32 v39, v61, v71
    v_lshlrev_b32 v64, 16, v116
    v_and_b32 v65, s53, v116
    v_lshlrev_b32 v66, 16, v117
    v_and_b32 v67, s53, v117
    v_lshlrev_b32 v68, 16, v118
    v_and_b32 v69, s53, v118
    v_lshlrev_b32 v70, 16, v119
    v_and_b32 v71, s53, v119
    v_fmac_f32 v40, v61, v64
    v_fmac_f32 v41, v61, v65
    v_fmac_f32 v42, v61, v66
    v_fmac_f32 v43, v61, v67
    v_fmac_f32 v44, v61, v68
    v_fmac_f32 v45, v61, v69
    v_fmac_f32 v46, v61, v70
    v_fmac_f32 v47, v61, v71
    v_lshlrev_b32 v64, 16, v104
    v_and_b32 v65, s53, v104
    v_lshlrev_b32 v66, 16, v105
    v_and_b32 v67, s53, v105
    v_lshlrev_b32 v68, 16, v106
    v_and_b32 v69, s53, v106
    v_lshlrev_b32 v70, 16, v107
    v_and_b32 v71, s53, v107
    v_fmac_f32 v32, v62, v64
    v_fmac_f32 v33, v62, v65
    v_fmac_f32 v34, v62, v66
    v_fmac_f32 v35, v62, v67
    v_fmac_f32 v36, v62, v68
    v_fmac_f32 v37, v62, v69
    v_fmac_f32 v38, v62, v70
    v_fmac_f32 v39, v62, v71
    v_lshlrev_b32 v64, 16, v120
    v_and_b32 v65, s53, v120
    v_lshlrev_b32 v66, 16, v121
    v_and_b32 v67, s53, v121
    v_lshlrev_b32 v68, 16, v122
    v_and_b32 v69, s53, v122
    v_lshlrev_b32 v70, 16, v123
    v_and_b32 v71, s53, v123
    v_fmac_f32 v40, v62, v64
    v_fmac_f32 v41, v62, v65
    v_fmac_f32 v42, v62, v66
    v_fmac_f32 v43, v62, v67
    v_fmac_f32 v44, v62, v68
    v_fmac_f32 v45, v62, v69
    v_fmac_f32 v46, v62, v70
    v_fmac_f32 v47, v62, v71
    v_lshlrev_b32 v64, 16, v108
    v_and_b32 v65, s53, v108
    v_lshlrev_b32 v66, 16, v109
    v_and_b32 v67, s53, v109
    v_lshlrev_b32 v68, 16, v110
    v_and_b32 v69, s53, v110
    v_lshlrev_b32 v70, 16, v111
    v_and_b32 v71, s53, v111
    v_fmac_f32 v32, v63, v64
    v_fmac_f32 v33, v63, v65
    v_fmac_f32 v34, v63, v66
    v_fmac_f32 v35, v63, v67
    v_fmac_f32 v36, v63, v68
    v_fmac_f32 v37, v63, v69
    v_fmac_f32 v38, v63, v70
    v_fmac_f32 v39, v63, v71
    v_lshlrev_b32 v64, 16, v124
    v_and_b32 v65, s53, v124
    v_lshlrev_b32 v66, 16, v125
    v_and_b32 v67, s53, v125
    v_lshlrev_b32 v68, 16, v126
    v_and_b32 v69, s53, v126
    v_lshlrev_b32 v70, 16, v127
    v_and_b32 v71, s53, v127
    v_fmac_f32 v40, v63, v64
    v_fmac_f32 v41, v63, v65
    v_fmac_f32 v42, v63, v66
    v_fmac_f32 v43, v63, v67
    v_fmac_f32 v44, v63, v68
    v_fmac_f32 v45, v63, v69
    v_fmac_f32 v46, v63, v70
    v_fmac_f32 v47, v63, v71
    s_nop 1
    v_permlane32_swap_b32 v32, v40
    v_permlane32_swap_b32 v33, v41
    v_permlane32_swap_b32 v34, v42
    v_permlane32_swap_b32 v35, v43
    v_permlane32_swap_b32 v36, v44
    v_permlane32_swap_b32 v37, v45
    v_permlane32_swap_b32 v38, v46
    v_permlane32_swap_b32 v39, v47
    s_nop 1
    v_add_f32 v32, v32, v40
    v_add_f32 v33, v33, v41
    v_add_f32 v34, v34, v42
    v_add_f32 v35, v35, v43
    v_add_f32 v36, v36, v44
    v_add_f32 v37, v37, v45
    v_add_f32 v38, v38, v46
    v_add_f32 v39, v39, v47
    s_nop 1
    v_permlane16_swap_b32 v32, v36
    v_permlane16_swap_b32 v33, v37
    v_permlane16_swap_b32 v34, v38
    v_permlane16_swap_b32 v35, v39
    s_nop 1
    v_add_f32 v32, v32, v36
    v_add_f32 v33, v33, v37
    v_add_f32 v34, v34, v38
    v_add_f32 v35, v35, v39
    s_nop 1
    v_add_f32_dpp v32, v32, v32 row_ror:4 row_mask:0xf bank_mask:0xf
    v_add_f32_dpp v33, v33, v33 row_ror:4 row_mask:0xf bank_mask:0xf
    v_add_f32_dpp v34, v34, v34 row_ror:4 row_mask:0xf bank_mask:0xf
    v_add_f32_dpp v35, v35, v35 row_ror:4 row_mask:0xf bank_mask:0xf
    s_nop 1
    v_add_f32_dpp v32, v32, v32 row_ror:8 row_mask:0xf bank_mask:0xf
    v_add_f32_dpp v33, v33, v33 row_ror:8 row_mask:0xf bank_mask:0xf
    v_add_f32_dpp v34, v34, v34 row_ror:8 row_mask:0xf bank_mask:0xf
    v_add_f32_dpp v35, v35, v35 row_ror:8 row_mask:0xf bank_mask:0xf
    v_and_b32 v9, 3, v2
    v_lshlrev_b32 v9, 5, v9
    v_bfe_u32 v10, v2, 4, 1
    v_lshl_add_u32 v9, v10, 4, v9
    v_bfe_u32 v10, v2, 5, 1
    v_lshl_add_u32 v9, v10, 7, v9
    s_lshl_b32 s37, s32, 8
    v_add_u32 v9, s37, v9
    ds_write_b128 v9, v[32:35] offset:128
    s_waitcnt lgkmcnt(0)
    s_barrier
    v_lshlrev_b32 v9, 2, v2
    ds_read_b32 v56, v9 offset:128
    ds_read_b32 v57, v9 offset:384
    ds_read_b32 v58, v9 offset:640
    ds_read_b32 v59, v9 offset:896
    ds_read_b32 v60, v9 offset:1152
    ds_read_b32 v61, v9 offset:1408
    ds_read_b32 v62, v9 offset:1664
    ds_read_b32 v63, v9 offset:1920
    s_waitcnt lgkmcnt(0)
    v_add_f32 v56, v56, v57
    v_add_f32 v58, v58, v59
    v_add_f32 v60, v60, v61
    v_add_f32 v62, v62, v63
    v_add_f32 v56, v56, v58
    v_add_f32 v60, v60, v62
    v_add_f32 v56, v56, v60
    v_mov_b32 v60, v56
    s_nop 1
    v_permlane32_swap_b32 v56, v60
    s_nop 1
    v_cvt_pk_bf16_f32 v56, v56, v60
    v_and_b32 v60, s53, v56
    v_lshlrev_b32 v56, 16, v56
    v_mul_f32 v57, 0xbfb8aa3b, v56
    v_exp_f32 v57, v57
    s_nop 0
    v_add_f32 v57, 1.0, v57
    v_rcp_f32 v57, v57
    s_nop 0
    v_mul_f32 v56, v56, v57
    v_cvt_pk_bf16_f32 v56, v56, v56
    v_lshlrev_b32 v56, 16, v56
    v_mul_f32 v56, v56, v60
    v_cvt_pk_bf16_f32 v56, v56, v56
    v_lshlrev_b32 v56, 16, v56
    s_lshl_b32 s37, s32, 2
    s_add_u32 s36, s37, 0
    s_nop 0
    v_readlane_b32 s40, v56, s36
    s_add_u32 s36, s37, 1
    s_nop 0
    v_readlane_b32 s41, v56, s36
    s_add_u32 s36, s37, 2
    s_nop 0
    v_readlane_b32 s42, v56, s36
    s_add_u32 s36, s37, 3
    s_nop 0
    v_readlane_b32 s43, v56, s36
    v_lshlrev_b32 v64, 16, v16
    v_and_b32 v65, s53, v16
    v_lshlrev_b32 v66, 16, v17
    v_and_b32 v67, s53, v17
    v_lshlrev_b32 v68, 16, v18
    v_and_b32 v69, s53, v18
    v_lshlrev_b32 v70, 16, v19
    v_and_b32 v71, s53, v19
    v_mul_f32 v32, s40, v64
    v_mul_f32 v33, s40, v65
    v_mul_f32 v34, s40, v66
    v_mul_f32 v35, s40, v67
    v_mul_f32 v36, s40, v68
    v_mul_f32 v37, s40, v69
    v_mul_f32 v38, s40, v70
    v_mul_f32 v39, s40, v71
    v_lshlrev_b32 v64, 16, v20
    v_and_b32 v65, s53, v20
    v_lshlrev_b32 v66, 16, v21
    v_and_b32 v67, s53, v21
    v_lshlrev_b32 v68, 16, v22
    v_and_b32 v69, s53, v22
    v_lshlrev_b32 v70, 16, v23
    v_and_b32 v71, s53, v23
    v_fmac_f32 v32, s41, v64
    v_fmac_f32 v33, s41, v65
    v_fmac_f32 v34, s41, v66
    v_fmac_f32 v35, s41, v67
    v_fmac_f32 v36, s41, v68
    v_fmac_f32 v37, s41, v69
    v_fmac_f32 v38, s41, v70
    v_fmac_f32 v39, s41, v71
    v_lshlrev_b32 v64, 16, v24
    v_and_b32 v65, s53, v24
    v_lshlrev_b32 v66, 16, v25
    v_and_b32 v67, s53, v25
    v_lshlrev_b32 v68, 16, v26
    v_and_b32 v69, s53, v26
    v_lshlrev_b32 v70, 16, v27
    v_and_b32 v71, s53, v27
    v_fmac_f32 v32, s42, v64
    v_fmac_f32 v33, s42, v65
    v_fmac_f32 v34, s42, v66
    v_fmac_f32 v35, s42, v67
    v_fmac_f32 v36, s42, v68
    v_fmac_f32 v37, s42, v69
    v_fmac_f32 v38, s42, v70
    v_fmac_f32 v39, s42, v71
    v_lshlrev_b32 v64, 16, v28
    v_and_b32 v65, s53, v28
    v_lshlrev_b32 v66, 16, v29
    v_and_b32 v67, s53, v29
    v_lshlrev_b32 v68, 16, v30
    v_and_b32 v69, s53, v30
    v_lshlrev_b32 v70, 16, v31
    v_and_b32 v71, s53, v31
    v_fmac_f32 v32, s43, v64
    v_fmac_f32 v33, s43, v65
    v_fmac_f32 v34, s43, v66
    v_fmac_f32 v35, s43, v67
    v_fmac_f32 v36, s43, v68
    v_fmac_f32 v37, s43, v69
    v_fmac_f32 v38, s43, v70
    v_fmac_f32 v39, s43, v71
    s_lshl_b32 s37, s32, 11
    v_add_u32 v9, s37, v4
    ds_write_b128 v9, v[32:35] offset:4096
    ds_write_b128 v9, v[36:39] offset:4112
    s_waitcnt lgkmcnt(0)
    s_barrier
    v_lshlrev_b32 v9, 2, v0
    ds_read_b32 v56, v9 offset:4096
    ds_read_b32 v57, v9 offset:6144
    ds_read_b32 v58, v9 offset:8192
    ds_read_b32 v59, v9 offset:10240
    ds_read_b32 v60, v9 offset:12288
    ds_read_b32 v61, v9 offset:14336
    ds_read_b32 v62, v9 offset:16384
    ds_read_b32 v63, v9 offset:18432
    s_lshl_b32 s37, s2, 12
    s_add_u32 s37, s37, 15728640
    v_lshlrev_b32 v9, 3, v0
    s_waitcnt lgkmcnt(0)
    v_add_f32 v56, v56, v57
    v_add_f32 v58, v58, v59
    v_add_f32 v60, v60, v61
    v_add_f32 v62, v62, v63
    v_add_f32 v56, v56, v58
    v_add_f32 v60, v60, v62
    v_add_f32 v56, v56, v60
    v_mov_b32 v57, v88
    buffer_store_dwordx2 v[56:57], v9, s[24:27], s37 offen sc0 sc1
    s_branch k1_kernelgt_fin2
k1_kernelgt_red:
    v_lshrrev_b32 v8, 4, v0
    v_and_b32 v9, 15, v0
    s_lshl_b32 s41, s52, 8
    s_add_u32 s42, s41, 15728640
    v_lshlrev_b32 v10, 12, v8
    v_lshl_add_u32 v10, v9, 4, v10
    v_add_u32 v11, 0x20000, v10
    v_cmp_gt_u32 s[54:55], 24, v8
    s_nop 1
    v_cndmask_b32 v11, v10, v11, s[54:55]
    s_lshl_b32 s43, s52, 7
    s_add_u32 s43, s43, s40
    v_lshlrev_b32 v12, 3, v9
    v_add_u32 v12, s43, v12
    s_and_b32 s44, s38, 0xffff0000
    s_xor_b32 s45, s44, 0x80000000
    s_not_b32 s46, s44
    s_and_b32 s46, s46, 0xffff0000
    s_cmp_ge_u32 s44, 0x80000000
    s_cselect_b32 s44, s45, s46
    v_mov_b32 v13, s44
    v_mul_f32 v13, 0xbfb8aa3b, v13
    v_exp_f32 v13, v13
    s_nop 0
    v_add_f32 v13, 1.0, v13
    v_rcp_f32 v13, v13
    s_nop 0
    v_cvt_pk_bf16_f32 v13, v13, v13
    v_lshlrev_b32 v13, 16, v13
k1_kernelgt_sp:
    buffer_load_dwordx4 v[56:59], v10, s[24:27], s42 offen sc1
    buffer_load_dwordx4 v[60:63], v11, s[24:27], s42 offen sc1
    buffer_load_dwordx2 v[64:65], v12, s[24:27], 0 offen sc1
    buffer_load_dwordx2 v[66:67], v12, s[24:27], 0 offen offset:2048 sc1
    s_waitcnt vmcnt(0)
    v_cmp_ne_u32 s[46:47], v57, v88
    v_cmp_ne_u32 vcc, v59, v88
    s_or_b64 s[46:47], s[46:47], vcc
    v_cmp_ne_u32 vcc, v61, v88
    s_or_b64 s[46:47], s[46:47], vcc
    v_cmp_ne_u32 vcc, v63, v88
    s_or_b64 s[46:47], s[46:47], vcc
    v_cmp_ne_u32 vcc, v65, v88
    s_or_b64 s[46:47], s[46:47], vcc
    v_cmp_ne_u32 vcc, v67, v88
    s_or_b64 s[46:47], s[46:47], vcc
    s_cbranch_scc0 k1_kernelgt_sd
    s_sleep 1
    s_sub_u32 s69, s69, 1
    s_cbranch_scc0 k1_kernelgt_sp
    s_mov_b32 s69, 0
k1_kernelgt_sd:
    v_cndmask_b32 v60, 0, v60, s[54:55]
    v_cndmask_b32 v62, 0, v62, s[54:55]
    v_add_f32 v56, v56, v60
    v_add_f32 v57, v58, v62
    v_mov_b32 v58, v56
    v_mov_b32 v59, v57
    s_nop 1
    v_permlane16_swap_b32 v56, v58
    v_permlane16_swap_b32 v57, v59
    s_nop 1
    v_add_f32 v56, v56, v58
    v_add_f32 v57, v57, v59
    v_mov_b32 v58, v56
    v_mov_b32 v59, v57
    s_nop 1
    v_permlane32_swap_b32 v56, v58
    v_permlane32_swap_b32 v57, v59
    s_nop 1
    v_add_f32 v56, v56, v58
    v_add_f32 v57, v57, v59
    v_lshlrev_b32 v10, 3, v9
    s_lshl_b32 s37, s32, 7
    v_add_u32 v11, s37, v10
    ds_write_b64 v11, v[56:57] offset:128
    s_waitcnt lgkmcnt(0)
    s_barrier
    s_cmp_lg_u32 s32, 0
    s_cbranch_scc1 k1_kernelgt_fin2
    ds_read_b64 v[32:33], v10 offset:128
    ds_read_b64 v[34:35], v10 offset:256
    ds_read_b64 v[36:37], v10 offset:384
    ds_read_b64 v[38:39], v10 offset:512
    ds_read_b64 v[40:41], v10 offset:640
    ds_read_b64 v[42:43], v10 offset:768
    ds_read_b64 v[44:45], v10 offset:896
    ds_read_b64 v[46:47], v10 offset:1024
    s_waitcnt lgkmcnt(0)
    v_add_f32 v32, v32, v34
    v_add_f32 v33, v33, v35
    v_add_f32 v36, v36, v38
    v_add_f32 v37, v37, v39
    v_add_f32 v40, v40, v42
    v_add_f32 v41, v41, v43
    v_add_f32 v44, v44, v46
    v_add_f32 v45, v45, v47
    v_add_f32 v32, v32, v36
    v_add_f32 v33, v33, v37
    v_add_f32 v40, v40, v44
    v_add_f32 v41, v41, v45
    v_add_f32 v32, v32, v40
    v_add_f32 v33, v33, v41
    v_cvt_pk_bf16_f32 v48, v32, v33
    v_lshlrev_b32 v32, 16, v48
    v_and_b32 v33, s53, v48
    v_mul_f32 v32, v32, v13
    v_mul_f32 v33, v33, v13
    v_cvt_pk_bf16_f32 v48, v32, v33
    v_lshlrev_b32 v32, 16, v48
    v_and_b32 v33, s53, v48
    v_lshlrev_b32 v49, 16, v66
    v_and_b32 v50, s53, v66
    v_add_f32 v32, v49, v32
    v_add_f32 v33, v50, v33
    v_cvt_pk_bf16_f32 v48, v32, v33
    v_lshlrev_b32 v32, 16, v48
    v_and_b32 v33, s53, v48
    v_lshlrev_b32 v49, 16, v64
    v_and_b32 v50, s53, v64
    v_add_f32 v32, v49, v32
    v_add_f32 v33, v50, v33
    v_cvt_pk_bf16_f32 v48, v32, v33
    s_lshl_b32 s39, s39, 10
    s_lshl_b32 s41, s52, 6
    s_add_u32 s39, s39, s41
    v_lshlrev_b32 v10, 2, v9
    v_add_u32 v10, s39, v10
    buffer_store_dword v48, v10, s[20:23], 0 offen
k1_kernelgt_fin2:
k1_kernelgt_fin:
k1_kernelg_done:
    s_endpgm
k1_kernel_done:
    s_endpgm
code_end:
.section .rodata,"a"
.p2align 6
.amdhsa_kernel k1_kernel
  .amdhsa_next_free_vgpr 208
  .amdhsa_next_free_sgpr 72
  .amdhsa_accum_offset 208
  .amdhsa_group_segment_fixed_size 0
  .amdhsa_kernarg_size 104
  .amdhsa_user_sgpr_count 2
  .amdhsa_user_sgpr_kernarg_segment_ptr 1
  .amdhsa_system_sgpr_workgroup_id_x 1
  .amdhsa_float_denorm_mode_32 3
.end_amdhsa_kernel
```
